```python
import torch

def _softmax(x, axis=-1):
    return torch.softmax(x, dim=axis)
def _gelu(x):
    return torch.nn.functional.gelu(x, approximate="tanh")
def _silu(x):
    return torch.nn.functional.silu(x)
def _sigmoid(x):
    return torch.sigmoid(x)
def _layernorm(x, axis=-1, eps=1e-5):
    m = x.mean(dim=axis, keepdim=True)
    v = x.var(dim=axis, keepdim=True, unbiased=False)
    return (x - m) / torch.sqrt(v + eps)
def _scatter_add(tgt, idx, src, axis=0):
    return tgt.clone().index_add_(axis, idx, src)
def _segment_sum(src, seg, n):
    out = torch.zeros((n,) + src.shape[1:], dtype=src.dtype)
    return out.index_add_(0, seg, src)
def _pad(x, pw):
    flat = tuple(v for pair in reversed(pw) for v in pair)
    return torch.nn.functional.pad(x, flat)

kernel_name = 'gated_mix__gqa_block_cached__glu_gated_bilinear__decode'

def setup_inputs():

    _w = (lambda a: (lambda t: t.to(torch.bfloat16) if t.is_floating_point() else t)(torch.as_tensor(a)))
    def _A_setup():
        B, Sq, D = 1, 1, 640
        Hq, Hkv, Sk, Dh = 32, 32, 8192, 192
        assert Hq % Hkv == 0, (Hq, Hkv)
        return {
            "x": _w((lambda *s: torch.randn(*s, dtype=torch.bfloat16) * 0.05)(B, Sq, D)),
            "k_cache": _w((lambda *s: torch.randn(*s, dtype=torch.bfloat16) * 3.2)(B, Hkv, Sk, Dh)),
            "v_cache": _w((lambda *s: torch.randn(*s, dtype=torch.bfloat16) * 0.05)(B, Hkv, Sk, Dh)),
            "wq": _w((lambda *s: torch.randn(*s, dtype=torch.bfloat16) * 3.2)(D, Hq * Dh) * (D ** -0.5)),
            "wo": _w((lambda *s: torch.randn(*s, dtype=torch.bfloat16) * 0.05)(Hq * Dh, D) * ((Hq * Dh) ** -0.5)),
        }
    _A_in = _A_setup()

    def _B_setup():
        B, S, D, F = 1, 1, 640, 1536
        return {
            "x": _w((lambda *s: torch.randn(*s, dtype=torch.bfloat16) * 0.05)(B, S, D)),
            "w_gate": _w((lambda *s: torch.randn(*s, dtype=torch.bfloat16) * 0.2)(D, F) * (D ** -0.5)),
            "w_up": _w((lambda *s: torch.randn(*s, dtype=torch.bfloat16) * 0.2)(D, F) * (D ** -0.5)),
            "w_down": _w((lambda *s: torch.randn(*s, dtype=torch.bfloat16) * 0.2)(F, D) * (F ** -0.5)),
        }
    _B_in = _B_setup()

    return {
        "A_x": _A_in["x"],
        "A_k_cache": _A_in["k_cache"],
        "A_v_cache": _A_in["v_cache"],
        "A_wq": _A_in["wq"],
        "A_wo": _A_in["wo"],
        "B_x": _B_in["x"],
        "B_w_gate": _B_in["w_gate"],
        "B_w_up": _B_in["w_up"],
        "B_w_down": _B_in["w_down"],
        "gate_w": _w((lambda *s: torch.randn(*s, dtype=torch.bfloat16) * 0.05)(640) * 16.0),
    }

def reference(A_x, A_k_cache, A_v_cache, A_wq, A_wo, B_x, B_w_gate, B_w_up, B_w_down, gate_w):
    def _A_ref(x, k_cache, v_cache, wq, wo):
        B, Sq, D = x.shape
        Hq, Dh = 32, 192
        Hkv = k_cache.shape[1]
        rep = Hq // Hkv
        q = (lambda x, *d: x.permute(*d))((x @ wq).reshape(B, Sq, Hq, Dh), 0, 2, 1, 3)
        k = (lambda x, n, axis: torch.repeat_interleave(x, n, dim=axis))(k_cache, rep, axis=1)
        v = (lambda x, n, axis: torch.repeat_interleave(x, n, dim=axis))(v_cache, rep, axis=1)
        scores = torch.einsum("bhqd,bhkd->bhqk", q, k) * (Dh ** -0.5)
        p = _softmax(scores, axis=-1)
        o = torch.einsum("bhqk,bhkd->bhqd", p, v)
        return (lambda x, *d: x.permute(*d))(o, 0, 2, 1, 3).reshape(B, Sq, Hq * Dh) @ wo

    def _B_ref(x, w_gate, w_up, w_down):
        g = torch.einsum("bsd,df->bsf", x, w_gate)
        u = torch.einsum("bsd,df->bsf", x, w_up)
        h = g * u
        return torch.einsum("bsf,fd->bsd", h, w_down)

    x = A_x
    g = _sigmoid((x * gate_w).sum(-1, keepdims=True))
    a = _A_ref(x, A_k_cache, A_v_cache, A_wq, A_wo)
    b = _B_ref(x, B_w_gate, B_w_up, B_w_down)
    return g * a + (1 - g) * b
```

```asm
; @launch grid=(256,1,1) block=(512,1,1) lds=150016
.amdgcn_target "amdgcn-amd-amdhsa--gfx950"
.text
.globl gated_mix__gqa_block_cached__glu_gated_bilinear__decode_kernel
.p2align 8
.type gated_mix__gqa_block_cached__glu_gated_bilinear__decode_kernel,@function
gated_mix__gqa_block_cached__glu_gated_bilinear__decode_kernel:
    s_cmp_ge_u32 s2, 256
    s_cbranch_scc1 L_end
    s_load_dwordx16 s[36:51], s[0:1], 0
    s_load_dwordx8 s[52:59], s[0:1], 64
    s_load_dwordx2 s[60:61], s[0:1], 96
    v_and_b32 v1, 63, v0
    v_lshrrev_b32 v7, 6, v0
    v_lshrrev_b32 v2, 4, v1
    v_and_b32 v3, 15, v1
    v_readfirstlane_b32 s63, v7
    s_and_b32 s3, s2, 31
    s_lshr_b32 s62, s2, 5
    s_lshl_b32 s78, s2, 12
    v_mul_u32_u24 v202, 384, v3
    v_lshl_add_u32 v202, v2, 4, v202
    v_lshlrev_b32 v4, 4, v1
    s_mul_i32 s79, s63, 12288
    s_add_u32 s79, s79, 51712
    v_add_u32 v202, s79, v202
    v_mul_u32_u24 v8, 1536, v2
    v_lshl_add_u32 v5, v3, 4, v8
    v_lshrrev_b32 v9, 3, v3
    v_mul_u32_u24 v9, 384, v9
    v_and_b32 v10, 7, v3
    v_lshlrev_b32 v10, 4, v10
    v_add3_u32 v6, v8, v9, v10
    v_add_u32 v6, 256, v6
    v_cmp_lt_u32 s[64:65], 7, v3
    v_cmp_gt_u32 vcc, 480, v0
    s_mov_b64 s[80:81], vcc
    s_mov_b32 s76, 0x3d93cd3a
    s_mov_b32 s77, 0x3fb8aa3b
    v_mul_u32_u24 v236, 2731, v0
    v_lshrrev_b32 v236, 16, v236
    v_mul_u32_u24 v237, 24, v236
    v_sub_u32 v237, v0, v237
    v_mul_u32_u24 v238, 5462, v0
    v_lshrrev_b32 v238, 16, v238
    v_mul_u32_u24 v239, 12, v238
    v_sub_u32 v239, v0, v239
    v_mov_b32 v240, -1
    v_mov_b32 v241, -1
    v_mov_b32 v242, -1
    v_mov_b32 v243, -1
    s_waitcnt lgkmcnt(0)
    s_mov_b32 s24, s60
    s_and_b32 s25, s61, 0xffff
    s_mov_b32 s26, 402653184
    s_mov_b32 s27, 0x00020000
    s_mov_b32 s28, s36
    s_and_b32 s29, s37, 0xffff
    s_mov_b32 s30, 1280
    s_mov_b32 s31, 0x00020000
    s_mov_b32 s12, s42
    s_and_b32 s13, s43, 0xffff
    s_mov_b32 s14, 7864320
    s_mov_b32 s15, 0x00020000
    s_mov_b32 s4, s38
    s_and_b32 s5, s39, 0xffff
    s_mov_b32 s6, 100663296
    s_mov_b32 s7, 0x00020000
    s_mov_b32 s8, s40
    s_and_b32 s9, s41, 0xffff
    s_mov_b32 s10, 100663296
    s_mov_b32 s11, 0x00020000
    s_mov_b32 s16, s44
    s_and_b32 s17, s45, 0xffff
    s_mov_b32 s18, 7864320
    s_mov_b32 s19, 0x00020000
    s_mov_b32 s20, s52
    s_and_b32 s21, s53, 0xffff
    s_mov_b32 s22, 1966080
    s_mov_b32 s23, 0x00020000
    s_mov_b32 s84, s54
    s_and_b32 s85, s55, 0xffff
    s_mov_b32 s86, 1280
    s_mov_b32 s87, 0x00020000
    s_mov_b32 s88, s56
    s_and_b32 s89, s57, 0xffff
    s_mov_b32 s90, 1280
    s_mov_b32 s91, 0x00020000
    s_mov_b32 s32, s58
    s_and_b32 s33, s59, 0xffff
    s_mov_b32 s34, 256
    s_mov_b32 s35, 0x00020000
    s_mov_b64 s[92:93], s[48:49]
    s_mov_b64 s[94:95], s[50:51]
    s_mul_i32 s72, s3, 3145728
    s_mul_i32 s66, s62, 393216
    s_add_u32 s72, s72, s66
    s_mul_i32 s66, s63, 6144
    s_add_u32 s72, s72, s66
    v_mov_b32 v15, 2130706432
    v_lshl_add_u32 v7, v0, 4, s78
    v_cmp_gt_u32 vcc, 97, v0
    v_mov_b32 v9, 0
    v_mov_b32 v10, 0
    v_cndmask_b32 v7, v15, v7, vcc
    buffer_store_dwordx4 v[240:243], v7, s[24:27], 0 offen offset:1152 sc1
    v_mov_b32 v8, 51200
    ds_write_b32 v8, v9
    ds_write_b32 v8, v9 offset:4
    ds_write_b32 v8, v9 offset:8
    s_mul_i32 s66, s62, 160
    v_lshlrev_b32 v8, 3, v236
    v_cndmask_b32 v8, v15, v8, s[80:81]
    buffer_load_dwordx2 v[192:193], v8, s[28:31], s66 offen
    v_lshlrev_b32 v9, 2, v238
    v_cndmask_b32 v9, v15, v9, s[80:81]
    buffer_load_dword v216, v9, s[28:31], s66 offen
    v_mul_u32_u24 v7, 3072, v236
    v_add_u32 v7, v7, v237
    v_lshlrev_b32 v7, 4, v7
    v_cndmask_b32 v7, v15, v7, s[80:81]
    s_mul_i32 s66, s3, 384
    s_mul_i32 s67, s62, 983040
    s_add_u32 s66, s66, s67
    buffer_load_dwordx4 v[64:67], v7, s[12:15], s66 offen nt
    s_add_u32 s66, s66, 12288
    buffer_load_dwordx4 v[68:71], v7, s[12:15], s66 offen nt
    s_add_u32 s66, s66, 12288
    buffer_load_dwordx4 v[72:75], v7, s[12:15], s66 offen nt
    s_add_u32 s66, s66, 12288
    buffer_load_dwordx4 v[76:79], v7, s[12:15], s66 offen nt
    v_min_u32 v10, 39, v238
    v_cmp_gt_u32 vcc, 6, v239
    v_subrev_u32 v11, 6, v239
    v_mov_b32 v12, s94
    v_mov_b32 v13, s95
    v_cndmask_b32 v11, v11, v239, vcc
    v_mov_b32 v7, s92
    v_mov_b32 v8, s93
    v_cndmask_b32 v12, v12, v7, vcc
    v_cndmask_b32 v13, v13, v8, vcc
    s_mul_i32 s66, s62, 245760
    s_mul_i32 s67, s3, 96
    s_add_u32 s66, s66, s67
    v_mul_u32_u24 v10, 6144, v10
    v_lshl_add_u32 v10, v11, 4, v10
    v_add_u32 v10, s66, v10
    v_add_co_u32 v244, vcc, v12, v10
    s_nop 1
    v_addc_co_u32 v245, vcc, 0, v13, vcc
    global_load_dwordx4 v[208:211], v[244:245], off nt
    global_load_dwordx4 v[212:215], v[244:245], off offset:3072 nt
    v_mul_u32_u24 v201, 6554, v0
    v_lshrrev_b32 v201, 16, v201
    v_mul_u32_u24 v10, 10, v201
    v_sub_u32 v10, v0, v10
    v_mul_u32_u24 v200, 1280, v201
    v_lshl_add_u32 v200, v10, 4, v200
    v_cndmask_b32 v200, v15, v200, s[80:81]
    s_add_u32 s73, s72, 49152
    s_add_u32 s74, s72, 98304
    s_add_u32 s101, s72, 147456
    s_waitcnt vmcnt(0)
    s_add_u32 m0, s79, 0
    s_add_u32 s100, s72, 4096
    buffer_load_dwordx4 v4, s[4:7], s72 offen offset:0 nt lds
    buffer_load_dwordx4 v4, s[4:7], s72 offen offset:1024 nt lds
    buffer_load_dwordx4 v4, s[4:7], s72 offen offset:2048 nt lds
    buffer_load_dwordx4 v4, s[4:7], s72 offen offset:3072 nt lds
    s_add_u32 m0, s79, 4096
    s_nop 0
    buffer_load_dwordx4 v4, s[4:7], s100 offen offset:0 nt lds
    buffer_load_dwordx4 v4, s[4:7], s100 offen offset:1024 nt lds
    v_lshlrev_b32 v8, 16, v192
    v_lshlrev_b32 v9, 16, v64
    v_and_b32 v10, 0xffff0000, v64
    v_mul_f32 v220, v8, v9
    v_mul_f32 v221, v8, v10
    v_lshlrev_b32 v9, 16, v65
    v_and_b32 v10, 0xffff0000, v65
    v_mul_f32 v222, v8, v9
    v_mul_f32 v223, v8, v10
    v_lshlrev_b32 v9, 16, v66
    v_and_b32 v10, 0xffff0000, v66
    v_mul_f32 v224, v8, v9
    v_mul_f32 v225, v8, v10
    v_lshlrev_b32 v9, 16, v67
    v_and_b32 v10, 0xffff0000, v67
    v_mul_f32 v226, v8, v9
    v_mul_f32 v227, v8, v10
    v_and_b32 v8, 0xffff0000, v192
    v_lshlrev_b32 v9, 16, v68
    v_and_b32 v10, 0xffff0000, v68
    v_fmac_f32 v220, v8, v9
    v_fmac_f32 v221, v8, v10
    v_lshlrev_b32 v9, 16, v69
    v_and_b32 v10, 0xffff0000, v69
    v_fmac_f32 v222, v8, v9
    v_fmac_f32 v223, v8, v10
    v_lshlrev_b32 v9, 16, v70
    v_and_b32 v10, 0xffff0000, v70
    v_fmac_f32 v224, v8, v9
    v_fmac_f32 v225, v8, v10
    v_lshlrev_b32 v9, 16, v71
    v_and_b32 v10, 0xffff0000, v71
    v_fmac_f32 v226, v8, v9
    v_fmac_f32 v227, v8, v10
    v_lshlrev_b32 v8, 16, v193
    v_lshlrev_b32 v9, 16, v72
    v_and_b32 v10, 0xffff0000, v72
    v_fmac_f32 v220, v8, v9
    v_fmac_f32 v221, v8, v10
    v_lshlrev_b32 v9, 16, v73
    v_and_b32 v10, 0xffff0000, v73
    v_fmac_f32 v222, v8, v9
    v_fmac_f32 v223, v8, v10
    v_lshlrev_b32 v9, 16, v74
    v_and_b32 v10, 0xffff0000, v74
    v_fmac_f32 v224, v8, v9
    v_fmac_f32 v225, v8, v10
    v_lshlrev_b32 v9, 16, v75
    v_and_b32 v10, 0xffff0000, v75
    v_fmac_f32 v226, v8, v9
    v_fmac_f32 v227, v8, v10
    v_and_b32 v8, 0xffff0000, v193
    v_lshlrev_b32 v9, 16, v76
    v_and_b32 v10, 0xffff0000, v76
    v_fmac_f32 v220, v8, v9
    v_fmac_f32 v221, v8, v10
    v_lshlrev_b32 v9, 16, v77
    v_and_b32 v10, 0xffff0000, v77
    v_fmac_f32 v222, v8, v9
    v_fmac_f32 v223, v8, v10
    v_lshlrev_b32 v9, 16, v78
    v_and_b32 v10, 0xffff0000, v78
    v_fmac_f32 v224, v8, v9
    v_fmac_f32 v225, v8, v10
    v_lshlrev_b32 v9, 16, v79
    v_and_b32 v10, 0xffff0000, v79
    v_fmac_f32 v226, v8, v9
    v_fmac_f32 v227, v8, v10
    v_lshlrev_b32 v8, 16, v216
    v_lshlrev_b32 v9, 16, v208
    v_and_b32 v10, 0xffff0000, v208
    v_mul_f32 v228, v8, v9
    v_mul_f32 v229, v8, v10
    v_lshlrev_b32 v9, 16, v209
    v_and_b32 v10, 0xffff0000, v209
    v_mul_f32 v230, v8, v9
    v_mul_f32 v231, v8, v10
    v_lshlrev_b32 v9, 16, v210
    v_and_b32 v10, 0xffff0000, v210
    v_mul_f32 v232, v8, v9
    v_mul_f32 v233, v8, v10
    v_lshlrev_b32 v9, 16, v211
    v_and_b32 v10, 0xffff0000, v211
    v_mul_f32 v234, v8, v9
    v_mul_f32 v235, v8, v10
    v_and_b32 v8, 0xffff0000, v216
    v_lshlrev_b32 v9, 16, v212
    v_and_b32 v10, 0xffff0000, v212
    v_fmac_f32 v228, v8, v9
    v_fmac_f32 v229, v8, v10
    v_lshlrev_b32 v9, 16, v213
    v_and_b32 v10, 0xffff0000, v213
    v_fmac_f32 v230, v8, v9
    v_fmac_f32 v231, v8, v10
    v_lshlrev_b32 v9, 16, v214
    v_and_b32 v10, 0xffff0000, v214
    v_fmac_f32 v232, v8, v9
    v_fmac_f32 v233, v8, v10
    v_lshlrev_b32 v9, 16, v215
    v_and_b32 v10, 0xffff0000, v215
    v_fmac_f32 v234, v8, v9
    v_fmac_f32 v235, v8, v10
    v_mul_u32_u24 v8, 768, v236
    v_lshl_add_u32 v8, v237, 5, v8
    v_mul_u32_u24 v9, 384, v238
    v_lshl_add_u32 v9, v239, 5, v9
    s_mov_b64 s[70:71], exec
    s_mov_b64 exec, s[80:81]
    ds_write_b128 v8, v[220:223] offset:0
    ds_write_b128 v8, v[224:227] offset:16
    ds_write_b128 v9, v[228:231] offset:15360
    ds_write_b128 v9, v[232:235] offset:15376
    s_mov_b64 exec, s[70:71]
    s_waitcnt lgkmcnt(0)
    s_barrier
    s_cmp_lt_u32 s63, 5
    s_cbranch_scc1 L_a_wave
    buffer_load_dwordx4 v[40:43], v5, s[8:11], s72 offen offset:0 nt
    buffer_load_dwordx4 v[44:47], v5, s[8:11], s72 offen offset:384 nt
    buffer_load_dwordx4 v[48:51], v5, s[8:11], s72 offen offset:768 nt
    buffer_load_dwordx4 v[52:55], v5, s[8:11], s72 offen offset:1152 nt
    buffer_load_dwordx4 v[56:59], v6, s[8:11], s72 offen offset:0 nt
    buffer_load_dwordx4 v[60:63], v6, s[8:11], s72 offen offset:768 nt
    s_add_u32 m0, s79, 6144
    s_add_u32 s100, s73, 4096
    buffer_load_dwordx4 v4, s[4:7], s73 offen offset:0 nt lds
    buffer_load_dwordx4 v4, s[4:7], s73 offen offset:1024 nt lds
    buffer_load_dwordx4 v4, s[4:7], s73 offen offset:2048 nt lds
    buffer_load_dwordx4 v4, s[4:7], s73 offen offset:3072 nt lds
    s_add_u32 m0, s79, 10240
    s_nop 0
    buffer_load_dwordx4 v4, s[4:7], s100 offen offset:0 nt lds
    buffer_load_dwordx4 v4, s[4:7], s100 offen offset:1024 nt lds
    buffer_load_dwordx4 v[64:67], v5, s[8:11], s73 offen offset:0 nt
    buffer_load_dwordx4 v[68:71], v5, s[8:11], s73 offen offset:384 nt
    buffer_load_dwordx4 v[72:75], v5, s[8:11], s73 offen offset:768 nt
    buffer_load_dwordx4 v[76:79], v5, s[8:11], s73 offen offset:1152 nt
    buffer_load_dwordx4 v[80:83], v6, s[8:11], s73 offen offset:0 nt
    buffer_load_dwordx4 v[84:87], v6, s[8:11], s73 offen offset:768 nt
    buffer_load_dwordx4 v[88:91], v5, s[8:11], s74 offen offset:0 nt
    buffer_load_dwordx4 v[92:95], v5, s[8:11], s74 offen offset:384 nt
    buffer_load_dwordx4 v[96:99], v5, s[8:11], s74 offen offset:768 nt
    buffer_load_dwordx4 v[100:103], v5, s[8:11], s74 offen offset:1152 nt
    buffer_load_dwordx4 v[104:107], v6, s[8:11], s74 offen offset:0 nt
    buffer_load_dwordx4 v[108:111], v6, s[8:11], s74 offen offset:768 nt
    buffer_load_dwordx4 v[204:207], v5, s[8:11], s101 offen offset:0 nt
    buffer_load_dwordx4 v[208:211], v5, s[8:11], s101 offen offset:384 nt
    buffer_load_dwordx4 v[212:215], v5, s[8:11], s101 offen offset:768 nt
    buffer_load_dwordx4 v[216:219], v5, s[8:11], s101 offen offset:1152 nt
    buffer_load_dwordx4 v[220:223], v6, s[8:11], s101 offen offset:0 nt
    buffer_load_dwordx4 v[224:227], v6, s[8:11], s101 offen offset:768 nt
    s_branch L_a_done
L_a_wave:
    v_lshlrev_b32 v8, 2, v0
    s_cmp_ge_u32 s63, 3
    s_cbranch_scc1 L_a_notq
    ds_read_b32 v182, v8 offset:0
    ds_read_b32 v183, v8 offset:768
    ds_read_b32 v184, v8 offset:1536
    ds_read_b32 v185, v8 offset:2304
    ds_read_b32 v186, v8 offset:3072
    ds_read_b32 v187, v8 offset:3840
    ds_read_b32 v188, v8 offset:4608
    ds_read_b32 v189, v8 offset:5376
    ds_read_b32 v190, v8 offset:6144
    ds_read_b32 v191, v8 offset:6912
    ds_read_b32 v192, v8 offset:7680
    ds_read_b32 v193, v8 offset:8448
    ds_read_b32 v194, v8 offset:9216
    ds_read_b32 v195, v8 offset:9984
    ds_read_b32 v196, v8 offset:10752
    ds_read_b32 v197, v8 offset:11520
    ds_read_b32 v198, v8 offset:12288
    ds_read_b32 v199, v8 offset:13056
    ds_read_b32 v244, v8 offset:13824
    ds_read_b32 v245, v8 offset:14592
    s_waitcnt lgkmcnt(0)
    v_add_f32 v9, v182, v183
    v_add_f32 v9, v9, v184
    v_add_f32 v9, v9, v185
    v_add_f32 v9, v9, v186
    v_add_f32 v9, v9, v187
    v_add_f32 v9, v9, v188
    v_add_f32 v9, v9, v189
    v_add_f32 v9, v9, v190
    v_add_f32 v9, v9, v191
    v_add_f32 v9, v9, v192
    v_add_f32 v9, v9, v193
    v_add_f32 v9, v9, v194
    v_add_f32 v9, v9, v195
    v_add_f32 v9, v9, v196
    v_add_f32 v9, v9, v197
    v_add_f32 v9, v9, v198
    v_add_f32 v9, v9, v199
    v_add_f32 v9, v9, v244
    v_add_f32 v9, v9, v245
    s_branch L_a_pub
L_a_notq:
    v_subrev_u32 v10, 768, v8
    v_min_u32 v10, 380, v10
    ds_read_b32 v182, v10 offset:15360
    ds_read_b32 v183, v10 offset:15744
    ds_read_b32 v184, v10 offset:16128
    ds_read_b32 v185, v10 offset:16512
    ds_read_b32 v186, v10 offset:16896
    ds_read_b32 v187, v10 offset:17280
    ds_read_b32 v188, v10 offset:17664
    ds_read_b32 v189, v10 offset:18048
    ds_read_b32 v190, v10 offset:18432
    ds_read_b32 v191, v10 offset:18816
    ds_read_b32 v192, v10 offset:19200
    ds_read_b32 v193, v10 offset:19584
    ds_read_b32 v194, v10 offset:19968
    ds_read_b32 v195, v10 offset:20352
    ds_read_b32 v196, v10 offset:20736
    ds_read_b32 v197, v10 offset:21120
    ds_read_b32 v198, v10 offset:21504
    ds_read_b32 v199, v10 offset:21888
    ds_read_b32 v244, v10 offset:22272
    ds_read_b32 v245, v10 offset:22656
    s_waitcnt lgkmcnt(0)
    v_add_f32 v9, v182, v183
    v_add_f32 v9, v9, v184
    v_add_f32 v9, v9, v185
    v_add_f32 v9, v9, v186
    v_add_f32 v9, v9, v187
    v_add_f32 v9, v9, v188
    v_add_f32 v9, v9, v189
    v_add_f32 v9, v9, v190
    v_add_f32 v9, v9, v191
    v_add_f32 v9, v9, v192
    v_add_f32 v9, v9, v193
    v_add_f32 v9, v9, v194
    v_add_f32 v9, v9, v195
    v_add_f32 v9, v9, v196
    v_add_f32 v9, v9, v197
    v_add_f32 v9, v9, v198
    v_add_f32 v9, v9, v199
    v_add_f32 v9, v9, v244
    v_add_f32 v9, v9, v245
    ds_read_b32 v182, v10 offset:23040
    ds_read_b32 v183, v10 offset:23424
    ds_read_b32 v184, v10 offset:23808
    ds_read_b32 v185, v10 offset:24192
    ds_read_b32 v186, v10 offset:24576
    ds_read_b32 v187, v10 offset:24960
    ds_read_b32 v188, v10 offset:25344
    ds_read_b32 v189, v10 offset:25728
    ds_read_b32 v190, v10 offset:26112
    ds_read_b32 v191, v10 offset:26496
    ds_read_b32 v192, v10 offset:26880
    ds_read_b32 v193, v10 offset:27264
    ds_read_b32 v194, v10 offset:27648
    ds_read_b32 v195, v10 offset:28032
    ds_read_b32 v196, v10 offset:28416
    ds_read_b32 v197, v10 offset:28800
    ds_read_b32 v198, v10 offset:29184
    ds_read_b32 v199, v10 offset:29568
    ds_read_b32 v244, v10 offset:29952
    ds_read_b32 v245, v10 offset:30336
    s_waitcnt lgkmcnt(0)
    v_add_f32 v9, v9, v182
    v_add_f32 v9, v9, v183
    v_add_f32 v9, v9, v184
    v_add_f32 v9, v9, v185
    v_add_f32 v9, v9, v186
    v_add_f32 v9, v9, v187
    v_add_f32 v9, v9, v188
    v_add_f32 v9, v9, v189
    v_add_f32 v9, v9, v190
    v_add_f32 v9, v9, v191
    v_add_f32 v9, v9, v192
    v_add_f32 v9, v9, v193
    v_add_f32 v9, v9, v194
    v_add_f32 v9, v9, v195
    v_add_f32 v9, v9, v196
    v_add_f32 v9, v9, v197
    v_add_f32 v9, v9, v198
    v_add_f32 v9, v9, v199
    v_add_f32 v9, v9, v244
    v_add_f32 v9, v9, v245
L_a_pub:
    v_cmp_gt_u32 vcc, 288, v0
    v_add_u32 v10, s78, v8
    s_nop 0
    v_cndmask_b32 v10, v15, v10, vcc
    v_cndmask_b32 v12, v15, v8, vcc
    buffer_store_dword v9, v10, s[24:27], 0 offen offset:0 sc1
    v_mov_b32 v8, 51200
    v_mov_b32 v9, 1
    s_lshl_b32 s67, s3, 2
    v_mov_b32 v11, s67
    s_waitcnt vmcnt(0)
    v_cmp_eq_u32 vcc, 0, v1
    s_and_saveexec_b64 s[70:71], vcc
    ds_add_rtn_u32 v10, v8, v9
    s_waitcnt lgkmcnt(0)
    v_readfirstlane_b32 s66, v10
    s_cmp_lg_u32 s66, 4
    s_cbranch_scc1 L_a_noatom
    v_mov_b32 v10, 1
    buffer_atomic_add v10, v11, s[32:35], 0 offen offset:0 sc0 sc1
    s_waitcnt vmcnt(0)
    v_readfirstlane_b32 s66, v10
    s_cmp_lg_u32 s66, 7
    s_cbranch_scc1 L_a_noatom
    s_mov_b64 exec, 0xff
    s_lshl_b32 s66, s3, 12
    v_lshlrev_b32 v10, 17, v1
    buffer_store_dword v9, v10, s[24:27], s66 offen offset:2688 sc1
L_a_noatom:
    s_mov_b64 exec, s[70:71]
    s_cmp_lg_u32 s63, 0
    s_cbranch_scc1 L_a_others
    v_mov_b32 v11, s78
L_a_gpoll:
    buffer_load_dword v10, v11, s[24:27], 0 offen offset:2688 sc1
    s_waitcnt vmcnt(0)
    v_readfirstlane_b32 s66, v10
    s_cmp_eq_u32 s66, 1
    s_cbranch_scc1 L_a_gok
    s_sleep 2
    s_branch L_a_gpoll
L_a_gok:
    ds_write_b32 v8, v9 offset:4
    s_branch L_a_gather
L_a_others:
    buffer_load_dwordx4 v[40:43], v5, s[8:11], s72 offen offset:0 nt
    buffer_load_dwordx4 v[44:47], v5, s[8:11], s72 offen offset:384 nt
    buffer_load_dwordx4 v[48:51], v5, s[8:11], s72 offen offset:768 nt
    buffer_load_dwordx4 v[52:55], v5, s[8:11], s72 offen offset:1152 nt
    buffer_load_dwordx4 v[56:59], v6, s[8:11], s72 offen offset:0 nt
    buffer_load_dwordx4 v[60:63], v6, s[8:11], s72 offen offset:768 nt
    s_add_u32 m0, s79, 6144
    s_add_u32 s100, s73, 4096
    buffer_load_dwordx4 v4, s[4:7], s73 offen offset:0 nt lds
    buffer_load_dwordx4 v4, s[4:7], s73 offen offset:1024 nt lds
    buffer_load_dwordx4 v4, s[4:7], s73 offen offset:2048 nt lds
    buffer_load_dwordx4 v4, s[4:7], s73 offen offset:3072 nt lds
    s_add_u32 m0, s79, 10240
    s_nop 0
    buffer_load_dwordx4 v4, s[4:7], s100 offen offset:0 nt lds
    buffer_load_dwordx4 v4, s[4:7], s100 offen offset:1024 nt lds
    buffer_load_dwordx4 v[64:67], v5, s[8:11], s73 offen offset:0 nt
    buffer_load_dwordx4 v[68:71], v5, s[8:11], s73 offen offset:384 nt
    buffer_load_dwordx4 v[72:75], v5, s[8:11], s73 offen offset:768 nt
    buffer_load_dwordx4 v[76:79], v5, s[8:11], s73 offen offset:1152 nt
    buffer_load_dwordx4 v[80:83], v6, s[8:11], s73 offen offset:0 nt
    buffer_load_dwordx4 v[84:87], v6, s[8:11], s73 offen offset:768 nt
L_a_lspin:
    ds_read_b32 v10, v8 offset:4
    s_waitcnt lgkmcnt(0)
    v_readfirstlane_b32 s66, v10
    s_cmp_lg_u32 s66, 0
    s_cbranch_scc1 L_a_gather
    s_sleep 1
    s_branch L_a_lspin
L_a_gather:
    s_lshl_b32 s66, s3, 12
    buffer_load_dword v182, v12, s[24:27], s66 offen offset:0 sc1
    s_add_u32 s66, s66, 131072
    buffer_load_dword v183, v12, s[24:27], s66 offen offset:0 sc1
    s_add_u32 s66, s66, 131072
    buffer_load_dword v184, v12, s[24:27], s66 offen offset:0 sc1
    s_add_u32 s66, s66, 131072
    buffer_load_dword v185, v12, s[24:27], s66 offen offset:0 sc1
    s_add_u32 s66, s66, 131072
    buffer_load_dword v186, v12, s[24:27], s66 offen offset:0 sc1
    s_add_u32 s66, s66, 131072
    buffer_load_dword v187, v12, s[24:27], s66 offen offset:0 sc1
    s_add_u32 s66, s66, 131072
    buffer_load_dword v188, v12, s[24:27], s66 offen offset:0 sc1
    s_add_u32 s66, s66, 131072
    buffer_load_dword v189, v12, s[24:27], s66 offen offset:0 sc1
    s_cmp_lg_u32 s63, 0
    s_cbranch_scc1 L_a_g2
    buffer_load_dwordx4 v[40:43], v5, s[8:11], s72 offen offset:0 nt
    buffer_load_dwordx4 v[44:47], v5, s[8:11], s72 offen offset:384 nt
    buffer_load_dwordx4 v[48:51], v5, s[8:11], s72 offen offset:768 nt
    buffer_load_dwordx4 v[52:55], v5, s[8:11], s72 offen offset:1152 nt
    buffer_load_dwordx4 v[56:59], v6, s[8:11], s72 offen offset:0 nt
    buffer_load_dwordx4 v[60:63], v6, s[8:11], s72 offen offset:768 nt
    s_add_u32 m0, s79, 6144
    s_add_u32 s100, s73, 4096
    buffer_load_dwordx4 v4, s[4:7], s73 offen offset:0 nt lds
    buffer_load_dwordx4 v4, s[4:7], s73 offen offset:1024 nt lds
    buffer_load_dwordx4 v4, s[4:7], s73 offen offset:2048 nt lds
    buffer_load_dwordx4 v4, s[4:7], s73 offen offset:3072 nt lds
    s_add_u32 m0, s79, 10240
    s_nop 0
    buffer_load_dwordx4 v4, s[4:7], s100 offen offset:0 nt lds
    buffer_load_dwordx4 v4, s[4:7], s100 offen offset:1024 nt lds
    buffer_load_dwordx4 v[64:67], v5, s[8:11], s73 offen offset:0 nt
    buffer_load_dwordx4 v[68:71], v5, s[8:11], s73 offen offset:384 nt
    buffer_load_dwordx4 v[72:75], v5, s[8:11], s73 offen offset:768 nt
    buffer_load_dwordx4 v[76:79], v5, s[8:11], s73 offen offset:1152 nt
    buffer_load_dwordx4 v[80:83], v6, s[8:11], s73 offen offset:0 nt
    buffer_load_dwordx4 v[84:87], v6, s[8:11], s73 offen offset:768 nt
    buffer_load_dwordx4 v[88:91], v5, s[8:11], s74 offen offset:0 nt
    buffer_load_dwordx4 v[92:95], v5, s[8:11], s74 offen offset:384 nt
    buffer_load_dwordx4 v[96:99], v5, s[8:11], s74 offen offset:768 nt
    buffer_load_dwordx4 v[100:103], v5, s[8:11], s74 offen offset:1152 nt
    buffer_load_dwordx4 v[104:107], v6, s[8:11], s74 offen offset:0 nt
    buffer_load_dwordx4 v[108:111], v6, s[8:11], s74 offen offset:768 nt
    buffer_load_dwordx4 v[204:207], v5, s[8:11], s101 offen offset:0 nt
    buffer_load_dwordx4 v[208:211], v5, s[8:11], s101 offen offset:384 nt
    buffer_load_dwordx4 v[212:215], v5, s[8:11], s101 offen offset:768 nt
    buffer_load_dwordx4 v[216:219], v5, s[8:11], s101 offen offset:1152 nt
    buffer_load_dwordx4 v[220:223], v6, s[8:11], s101 offen offset:0 nt
    buffer_load_dwordx4 v[224:227], v6, s[8:11], s101 offen offset:768 nt
    s_waitcnt vmcnt(30)
    s_branch L_a_g3
L_a_g2:
    buffer_load_dwordx4 v[88:91], v5, s[8:11], s74 offen offset:0 nt
    buffer_load_dwordx4 v[92:95], v5, s[8:11], s74 offen offset:384 nt
    buffer_load_dwordx4 v[96:99], v5, s[8:11], s74 offen offset:768 nt
    buffer_load_dwordx4 v[100:103], v5, s[8:11], s74 offen offset:1152 nt
    buffer_load_dwordx4 v[104:107], v6, s[8:11], s74 offen offset:0 nt
    buffer_load_dwordx4 v[108:111], v6, s[8:11], s74 offen offset:768 nt
    buffer_load_dwordx4 v[204:207], v5, s[8:11], s101 offen offset:0 nt
    buffer_load_dwordx4 v[208:211], v5, s[8:11], s101 offen offset:384 nt
    buffer_load_dwordx4 v[212:215], v5, s[8:11], s101 offen offset:768 nt
    buffer_load_dwordx4 v[216:219], v5, s[8:11], s101 offen offset:1152 nt
    buffer_load_dwordx4 v[220:223], v6, s[8:11], s101 offen offset:0 nt
    buffer_load_dwordx4 v[224:227], v6, s[8:11], s101 offen offset:768 nt
    s_waitcnt vmcnt(12)
L_a_g3:
    v_add_f32 v9, v182, v183
    v_add_f32 v9, v9, v184
    v_add_f32 v9, v9, v185
    v_add_f32 v9, v9, v186
    v_add_f32 v9, v9, v187
    v_add_f32 v9, v9, v188
    v_add_f32 v9, v9, v189
    v_cvt_pk_bf16_f32 v9, v9, v9
    s_cmp_ge_u32 s63, 3
    s_cbranch_scc1 L_a_gus
    v_lshlrev_b32 v10, 1, v0
    ds_write_b16 v10, v9 offset:34816
    s_branch L_a_done
L_a_gus:
    v_lshlrev_b32 v9, 16, v9
    v_lshlrev_b32 v10, 2, v0
    v_cmp_gt_u32 vcc, 288, v0
    s_and_saveexec_b64 s[70:71], vcc
    ds_write_b32 v10, v9 offset:40832
    s_mov_b64 exec, s[70:71]
L_a_done:
    s_waitcnt lgkmcnt(0)
    s_barrier
    v_lshlrev_b32 v8, 4, v2
    ds_read_b128 v[112:115], v8 offset:34816
    ds_read_b128 v[116:119], v8 offset:34880
    ds_read_b128 v[120:123], v8 offset:34944
    ds_read_b128 v[124:127], v8 offset:35008
    ds_read_b128 v[128:131], v8 offset:35072
    ds_read_b128 v[132:135], v8 offset:35136
    v_mov_b32 v136, 0
    v_mov_b32 v137, 0
    v_mov_b32 v138, 0
    v_mov_b32 v139, 0
    v_mov_b32 v140, 0
    v_mov_b32 v141, 0
    v_mov_b32 v142, 0
    v_mov_b32 v143, 0
    v_mov_b32 v144, 0
    v_mov_b32 v145, 0
    v_mov_b32 v146, 0
    v_mov_b32 v147, 0
    v_mov_b32 v148, 0
    v_mov_b32 v149, 0
    v_mov_b32 v150, 0
    v_mov_b32 v151, 0
    v_mov_b32 v180, 0xff7fffff
    v_mov_b32 v181, 0
    s_mov_b32 s75, 0
    s_add_u32 s73, s72, 98304
    s_add_u32 s101, s72, 196608
    s_waitcnt lgkmcnt(0)
L_loop:
    s_cmp_eq_u32 s75, 0
    s_mov_b32 s66, s73
    s_cselect_b32 s67, s101, 2130706432
    s_waitcnt vmcnt(18)
    ds_read_b128 v[16:19], v202 offset:0
    ds_read_b128 v[20:23], v202 offset:64
    ds_read_b128 v[24:27], v202 offset:128
    ds_read_b128 v[28:31], v202 offset:192
    ds_read_b128 v[32:35], v202 offset:256
    ds_read_b128 v[36:39], v202 offset:320
    s_waitcnt lgkmcnt(0)
    s_add_u32 m0, s79, 0
    s_add_u32 s100, s66, 4096
    buffer_load_dwordx4 v4, s[4:7], s66 offen offset:0 nt lds
    buffer_load_dwordx4 v4, s[4:7], s66 offen offset:1024 nt lds
    buffer_load_dwordx4 v4, s[4:7], s66 offen offset:2048 nt lds
    buffer_load_dwordx4 v4, s[4:7], s66 offen offset:3072 nt lds
    s_add_u32 m0, s79, 4096
    s_nop 0
    buffer_load_dwordx4 v4, s[4:7], s100 offen offset:0 nt lds
    buffer_load_dwordx4 v4, s[4:7], s100 offen offset:1024 nt lds
    v_mfma_f32_16x16x32_bf16 v[172:175], v[16:19], v[112:115], 0
    v_mfma_f32_16x16x32_bf16 v[172:175], v[20:23], v[116:119], v[172:175]
    v_mfma_f32_16x16x32_bf16 v[172:175], v[24:27], v[120:123], v[172:175]
    v_mfma_f32_16x16x32_bf16 v[172:175], v[28:31], v[124:127], v[172:175]
    v_mfma_f32_16x16x32_bf16 v[172:175], v[32:35], v[128:131], v[172:175]
    v_mfma_f32_16x16x32_bf16 v[172:175], v[36:39], v[132:135], v[172:175]
    s_nop 7
    v_cvt_pk_bf16_f32 v182, v172, v173
    v_cvt_pk_bf16_f32 v183, v174, v175
    v_lshlrev_b32 v184, 16, v182
    v_and_b32 v185, 0xffff0000, v182
    v_lshlrev_b32 v186, 16, v183
    v_and_b32 v187, 0xffff0000, v183
    v_mul_f32 v184, s76, v184
    v_mul_f32 v185, s76, v185
    v_mul_f32 v186, s76, v186
    v_mul_f32 v187, s76, v187
    v_cvt_pk_bf16_f32 v182, v184, v185
    v_cvt_pk_bf16_f32 v183, v186, v187
    v_lshlrev_b32 v184, 16, v182
    v_and_b32 v185, 0xffff0000, v182
    v_lshlrev_b32 v186, 16, v183
    v_and_b32 v187, 0xffff0000, v183
    v_mul_f32 v184, s77, v184
    v_mul_f32 v185, s77, v185
    v_mul_f32 v186, s77, v186
    v_mul_f32 v187, s77, v187
    v_max3_f32 v188, v184, v185, v186
    v_max3_f32 v188, v188, v187, v180
    v_sub_f32 v189, v180, v188
    v_sub_f32 v176, v184, v188
    v_sub_f32 v177, v185, v188
    v_sub_f32 v178, v186, v188
    v_sub_f32 v179, v187, v188
    v_exp_f32 v189, v189
    v_exp_f32 v176, v176
    v_exp_f32 v177, v177
    v_exp_f32 v178, v178
    v_exp_f32 v179, v179
    v_mov_b32 v180, v188
    v_mul_f32 v136, v189, v136
    v_mul_f32 v137, v189, v137
    v_mul_f32 v138, v189, v138
    v_mul_f32 v139, v189, v139
    v_mul_f32 v140, v189, v140
    v_mul_f32 v141, v189, v141
    v_mul_f32 v142, v189, v142
    v_mul_f32 v143, v189, v143
    v_mul_f32 v144, v189, v144
    v_mul_f32 v145, v189, v145
    v_mul_f32 v146, v189, v146
    v_mul_f32 v147, v189, v147
    v_mul_f32 v148, v189, v148
    v_mul_f32 v149, v189, v149
    v_mul_f32 v150, v189, v150
    v_mul_f32 v151, v189, v151
    v_add_f32 v182, v176, v177
    v_add_f32 v183, v178, v179
    v_add_f32 v182, v182, v183
    v_fma_f32 v181, v181, v189, v182
    v_cndmask_b32 v190, v176, v177, s[64:65]
    v_cndmask_b32 v191, v178, v179, s[64:65]
    s_waitcnt vmcnt(18)
    v_lshlrev_b32 v192, 16, v40
    v_and_b32 v193, 0xffff0000, v40
    v_fmac_f32 v136, v176, v192
    v_fmac_f32 v137, v176, v193
    v_lshlrev_b32 v192, 16, v41
    v_and_b32 v193, 0xffff0000, v41
    v_fmac_f32 v138, v176, v192
    v_fmac_f32 v139, v176, v193
    v_lshlrev_b32 v192, 16, v42
    v_and_b32 v193, 0xffff0000, v42
    v_fmac_f32 v140, v176, v192
    v_fmac_f32 v141, v176, v193
    v_lshlrev_b32 v192, 16, v43
    v_and_b32 v193, 0xffff0000, v43
    v_fmac_f32 v142, v176, v192
    v_fmac_f32 v143, v176, v193
    v_lshlrev_b32 v192, 16, v44
    v_and_b32 v193, 0xffff0000, v44
    v_fmac_f32 v136, v177, v192
    v_fmac_f32 v137, v177, v193
    v_lshlrev_b32 v192, 16, v45
    v_and_b32 v193, 0xffff0000, v45
    v_fmac_f32 v138, v177, v192
    v_fmac_f32 v139, v177, v193
    v_lshlrev_b32 v192, 16, v46
    v_and_b32 v193, 0xffff0000, v46
    v_fmac_f32 v140, v177, v192
    v_fmac_f32 v141, v177, v193
    v_lshlrev_b32 v192, 16, v47
    v_and_b32 v193, 0xffff0000, v47
    v_fmac_f32 v142, v177, v192
    v_fmac_f32 v143, v177, v193
    v_lshlrev_b32 v192, 16, v48
    v_and_b32 v193, 0xffff0000, v48
    v_fmac_f32 v136, v178, v192
    v_fmac_f32 v137, v178, v193
    v_lshlrev_b32 v192, 16, v49
    v_and_b32 v193, 0xffff0000, v49
    v_fmac_f32 v138, v178, v192
    v_fmac_f32 v139, v178, v193
    v_lshlrev_b32 v192, 16, v50
    v_and_b32 v193, 0xffff0000, v50
    v_fmac_f32 v140, v178, v192
    v_fmac_f32 v141, v178, v193
    v_lshlrev_b32 v192, 16, v51
    v_and_b32 v193, 0xffff0000, v51
    v_fmac_f32 v142, v178, v192
    v_fmac_f32 v143, v178, v193
    v_lshlrev_b32 v192, 16, v52
    v_and_b32 v193, 0xffff0000, v52
    v_fmac_f32 v136, v179, v192
    v_fmac_f32 v137, v179, v193
    v_lshlrev_b32 v192, 16, v53
    v_and_b32 v193, 0xffff0000, v53
    v_fmac_f32 v138, v179, v192
    v_fmac_f32 v139, v179, v193
    v_lshlrev_b32 v192, 16, v54
    v_and_b32 v193, 0xffff0000, v54
    v_fmac_f32 v140, v179, v192
    v_fmac_f32 v141, v179, v193
    v_lshlrev_b32 v192, 16, v55
    v_and_b32 v193, 0xffff0000, v55
    v_fmac_f32 v142, v179, v192
    v_fmac_f32 v143, v179, v193
    v_lshlrev_b32 v192, 16, v56
    v_and_b32 v193, 0xffff0000, v56
    v_fmac_f32 v144, v190, v192
    v_fmac_f32 v145, v190, v193
    v_lshlrev_b32 v192, 16, v57
    v_and_b32 v193, 0xffff0000, v57
    v_fmac_f32 v146, v190, v192
    v_fmac_f32 v147, v190, v193
    v_lshlrev_b32 v192, 16, v58
    v_and_b32 v193, 0xffff0000, v58
    v_fmac_f32 v148, v190, v192
    v_fmac_f32 v149, v190, v193
    v_lshlrev_b32 v192, 16, v59
    v_and_b32 v193, 0xffff0000, v59
    v_fmac_f32 v150, v190, v192
    v_fmac_f32 v151, v190, v193
    v_lshlrev_b32 v192, 16, v60
    v_and_b32 v193, 0xffff0000, v60
    v_fmac_f32 v144, v191, v192
    v_fmac_f32 v145, v191, v193
    v_lshlrev_b32 v192, 16, v61
    v_and_b32 v193, 0xffff0000, v61
    v_fmac_f32 v146, v191, v192
    v_fmac_f32 v147, v191, v193
    v_lshlrev_b32 v192, 16, v62
    v_and_b32 v193, 0xffff0000, v62
    v_fmac_f32 v148, v191, v192
    v_fmac_f32 v149, v191, v193
    v_lshlrev_b32 v192, 16, v63
    v_and_b32 v193, 0xffff0000, v63
    v_fmac_f32 v150, v191, v192
    v_fmac_f32 v151, v191, v193
    buffer_load_dwordx4 v[40:43], v5, s[8:11], s67 offen offset:0 nt
    buffer_load_dwordx4 v[44:47], v5, s[8:11], s67 offen offset:384 nt
    buffer_load_dwordx4 v[48:51], v5, s[8:11], s67 offen offset:768 nt
    buffer_load_dwordx4 v[52:55], v5, s[8:11], s67 offen offset:1152 nt
    buffer_load_dwordx4 v[56:59], v6, s[8:11], s67 offen offset:0 nt
    buffer_load_dwordx4 v[60:63], v6, s[8:11], s67 offen offset:768 nt
    s_add_u32 s73, s73, 49152
    s_add_u32 s101, s101, 49152
    s_cmp_eq_u32 s75, 0
    s_mov_b32 s66, s73
    s_cselect_b32 s67, s101, 2130706432
    s_waitcnt vmcnt(18)
    ds_read_b128 v[16:19], v202 offset:6144
    ds_read_b128 v[20:23], v202 offset:6208
    ds_read_b128 v[24:27], v202 offset:6272
    ds_read_b128 v[28:31], v202 offset:6336
    ds_read_b128 v[32:35], v202 offset:6400
    ds_read_b128 v[36:39], v202 offset:6464
    s_waitcnt lgkmcnt(0)
    s_add_u32 m0, s79, 6144
    s_add_u32 s100, s66, 4096
    buffer_load_dwordx4 v4, s[4:7], s66 offen offset:0 nt lds
    buffer_load_dwordx4 v4, s[4:7], s66 offen offset:1024 nt lds
    buffer_load_dwordx4 v4, s[4:7], s66 offen offset:2048 nt lds
    buffer_load_dwordx4 v4, s[4:7], s66 offen offset:3072 nt lds
    s_add_u32 m0, s79, 10240
    s_nop 0
    buffer_load_dwordx4 v4, s[4:7], s100 offen offset:0 nt lds
    buffer_load_dwordx4 v4, s[4:7], s100 offen offset:1024 nt lds
    v_mfma_f32_16x16x32_bf16 v[172:175], v[16:19], v[112:115], 0
    v_mfma_f32_16x16x32_bf16 v[172:175], v[20:23], v[116:119], v[172:175]
    v_mfma_f32_16x16x32_bf16 v[172:175], v[24:27], v[120:123], v[172:175]
    v_mfma_f32_16x16x32_bf16 v[172:175], v[28:31], v[124:127], v[172:175]
    v_mfma_f32_16x16x32_bf16 v[172:175], v[32:35], v[128:131], v[172:175]
    v_mfma_f32_16x16x32_bf16 v[172:175], v[36:39], v[132:135], v[172:175]
    s_nop 7
    v_cvt_pk_bf16_f32 v182, v172, v173
    v_cvt_pk_bf16_f32 v183, v174, v175
    v_lshlrev_b32 v184, 16, v182
    v_and_b32 v185, 0xffff0000, v182
    v_lshlrev_b32 v186, 16, v183
    v_and_b32 v187, 0xffff0000, v183
    v_mul_f32 v184, s76, v184
    v_mul_f32 v185, s76, v185
    v_mul_f32 v186, s76, v186
    v_mul_f32 v187, s76, v187
    v_cvt_pk_bf16_f32 v182, v184, v185
    v_cvt_pk_bf16_f32 v183, v186, v187
    v_lshlrev_b32 v184, 16, v182
    v_and_b32 v185, 0xffff0000, v182
    v_lshlrev_b32 v186, 16, v183
    v_and_b32 v187, 0xffff0000, v183
    v_mul_f32 v184, s77, v184
    v_mul_f32 v185, s77, v185
    v_mul_f32 v186, s77, v186
    v_mul_f32 v187, s77, v187
    v_max3_f32 v188, v184, v185, v186
    v_max3_f32 v188, v188, v187, v180
    v_sub_f32 v189, v180, v188
    v_sub_f32 v176, v184, v188
    v_sub_f32 v177, v185, v188
    v_sub_f32 v178, v186, v188
    v_sub_f32 v179, v187, v188
    v_exp_f32 v189, v189
    v_exp_f32 v176, v176
    v_exp_f32 v177, v177
    v_exp_f32 v178, v178
    v_exp_f32 v179, v179
    v_mov_b32 v180, v188
    v_mul_f32 v136, v189, v136
    v_mul_f32 v137, v189, v137
    v_mul_f32 v138, v189, v138
    v_mul_f32 v139, v189, v139
    v_mul_f32 v140, v189, v140
    v_mul_f32 v141, v189, v141
    v_mul_f32 v142, v189, v142
    v_mul_f32 v143, v189, v143
    v_mul_f32 v144, v189, v144
    v_mul_f32 v145, v189, v145
    v_mul_f32 v146, v189, v146
    v_mul_f32 v147, v189, v147
    v_mul_f32 v148, v189, v148
    v_mul_f32 v149, v189, v149
    v_mul_f32 v150, v189, v150
    v_mul_f32 v151, v189, v151
    v_add_f32 v182, v176, v177
    v_add_f32 v183, v178, v179
    v_add_f32 v182, v182, v183
    v_fma_f32 v181, v181, v189, v182
    v_cndmask_b32 v190, v176, v177, s[64:65]
    v_cndmask_b32 v191, v178, v179, s[64:65]
    s_waitcnt vmcnt(18)
    v_lshlrev_b32 v192, 16, v64
    v_and_b32 v193, 0xffff0000, v64
    v_fmac_f32 v136, v176, v192
    v_fmac_f32 v137, v176, v193
    v_lshlrev_b32 v192, 16, v65
    v_and_b32 v193, 0xffff0000, v65
    v_fmac_f32 v138, v176, v192
    v_fmac_f32 v139, v176, v193
    v_lshlrev_b32 v192, 16, v66
    v_and_b32 v193, 0xffff0000, v66
    v_fmac_f32 v140, v176, v192
    v_fmac_f32 v141, v176, v193
    v_lshlrev_b32 v192, 16, v67
    v_and_b32 v193, 0xffff0000, v67
    v_fmac_f32 v142, v176, v192
    v_fmac_f32 v143, v176, v193
    v_lshlrev_b32 v192, 16, v68
    v_and_b32 v193, 0xffff0000, v68
    v_fmac_f32 v136, v177, v192
    v_fmac_f32 v137, v177, v193
    v_lshlrev_b32 v192, 16, v69
    v_and_b32 v193, 0xffff0000, v69
    v_fmac_f32 v138, v177, v192
    v_fmac_f32 v139, v177, v193
    v_lshlrev_b32 v192, 16, v70
    v_and_b32 v193, 0xffff0000, v70
    v_fmac_f32 v140, v177, v192
    v_fmac_f32 v141, v177, v193
    v_lshlrev_b32 v192, 16, v71
    v_and_b32 v193, 0xffff0000, v71
    v_fmac_f32 v142, v177, v192
    v_fmac_f32 v143, v177, v193
    v_lshlrev_b32 v192, 16, v72
    v_and_b32 v193, 0xffff0000, v72
    v_fmac_f32 v136, v178, v192
    v_fmac_f32 v137, v178, v193
    v_lshlrev_b32 v192, 16, v73
    v_and_b32 v193, 0xffff0000, v73
    v_fmac_f32 v138, v178, v192
    v_fmac_f32 v139, v178, v193
    v_lshlrev_b32 v192, 16, v74
    v_and_b32 v193, 0xffff0000, v74
    v_fmac_f32 v140, v178, v192
    v_fmac_f32 v141, v178, v193
    v_lshlrev_b32 v192, 16, v75
    v_and_b32 v193, 0xffff0000, v75
    v_fmac_f32 v142, v178, v192
    v_fmac_f32 v143, v178, v193
    v_lshlrev_b32 v192, 16, v76
    v_and_b32 v193, 0xffff0000, v76
    v_fmac_f32 v136, v179, v192
    v_fmac_f32 v137, v179, v193
    v_lshlrev_b32 v192, 16, v77
    v_and_b32 v193, 0xffff0000, v77
    v_fmac_f32 v138, v179, v192
    v_fmac_f32 v139, v179, v193
    v_lshlrev_b32 v192, 16, v78
    v_and_b32 v193, 0xffff0000, v78
    v_fmac_f32 v140, v179, v192
    v_fmac_f32 v141, v179, v193
    v_lshlrev_b32 v192, 16, v79
    v_and_b32 v193, 0xffff0000, v79
    v_fmac_f32 v142, v179, v192
    v_fmac_f32 v143, v179, v193
    v_lshlrev_b32 v192, 16, v80
    v_and_b32 v193, 0xffff0000, v80
    v_fmac_f32 v144, v190, v192
    v_fmac_f32 v145, v190, v193
    v_lshlrev_b32 v192, 16, v81
    v_and_b32 v193, 0xffff0000, v81
    v_fmac_f32 v146, v190, v192
    v_fmac_f32 v147, v190, v193
    v_lshlrev_b32 v192, 16, v82
    v_and_b32 v193, 0xffff0000, v82
    v_fmac_f32 v148, v190, v192
    v_fmac_f32 v149, v190, v193
    v_lshlrev_b32 v192, 16, v83
    v_and_b32 v193, 0xffff0000, v83
    v_fmac_f32 v150, v190, v192
    v_fmac_f32 v151, v190, v193
    v_lshlrev_b32 v192, 16, v84
    v_and_b32 v193, 0xffff0000, v84
    v_fmac_f32 v144, v191, v192
    v_fmac_f32 v145, v191, v193
    v_lshlrev_b32 v192, 16, v85
    v_and_b32 v193, 0xffff0000, v85
    v_fmac_f32 v146, v191, v192
    v_fmac_f32 v147, v191, v193
    v_lshlrev_b32 v192, 16, v86
    v_and_b32 v193, 0xffff0000, v86
    v_fmac_f32 v148, v191, v192
    v_fmac_f32 v149, v191, v193
    v_lshlrev_b32 v192, 16, v87
    v_and_b32 v193, 0xffff0000, v87
    v_fmac_f32 v150, v191, v192
    v_fmac_f32 v151, v191, v193
    buffer_load_dwordx4 v[64:67], v5, s[8:11], s67 offen offset:0 nt
    buffer_load_dwordx4 v[68:71], v5, s[8:11], s67 offen offset:384 nt
    buffer_load_dwordx4 v[72:75], v5, s[8:11], s67 offen offset:768 nt
    buffer_load_dwordx4 v[76:79], v5, s[8:11], s67 offen offset:1152 nt
    buffer_load_dwordx4 v[80:83], v6, s[8:11], s67 offen offset:0 nt
    buffer_load_dwordx4 v[84:87], v6, s[8:11], s67 offen offset:768 nt
    s_add_u32 s73, s73, 49152
    s_add_u32 s101, s101, 49152
    s_cmp_eq_u32 s75, 0
    s_cselect_b32 s66, s73, 2130706432
    s_cselect_b32 s67, s101, 2130706432
    s_waitcnt vmcnt(18)
    ds_read_b128 v[16:19], v202 offset:0
    ds_read_b128 v[20:23], v202 offset:64
    ds_read_b128 v[24:27], v202 offset:128
    ds_read_b128 v[28:31], v202 offset:192
    ds_read_b128 v[32:35], v202 offset:256
    ds_read_b128 v[36:39], v202 offset:320
    s_waitcnt lgkmcnt(0)
    s_add_u32 m0, s79, 0
    s_add_u32 s100, s66, 4096
    buffer_load_dwordx4 v4, s[4:7], s66 offen offset:0 nt lds
    buffer_load_dwordx4 v4, s[4:7], s66 offen offset:1024 nt lds
    buffer_load_dwordx4 v4, s[4:7], s66 offen offset:2048 nt lds
    buffer_load_dwordx4 v4, s[4:7], s66 offen offset:3072 nt lds
    s_add_u32 m0, s79, 4096
    s_nop 0
    buffer_load_dwordx4 v4, s[4:7], s100 offen offset:0 nt lds
    buffer_load_dwordx4 v4, s[4:7], s100 offen offset:1024 nt lds
    v_mfma_f32_16x16x32_bf16 v[172:175], v[16:19], v[112:115], 0
    v_mfma_f32_16x16x32_bf16 v[172:175], v[20:23], v[116:119], v[172:175]
    v_mfma_f32_16x16x32_bf16 v[172:175], v[24:27], v[120:123], v[172:175]
    v_mfma_f32_16x16x32_bf16 v[172:175], v[28:31], v[124:127], v[172:175]
    v_mfma_f32_16x16x32_bf16 v[172:175], v[32:35], v[128:131], v[172:175]
    v_mfma_f32_16x16x32_bf16 v[172:175], v[36:39], v[132:135], v[172:175]
    s_nop 7
    v_cvt_pk_bf16_f32 v182, v172, v173
    v_cvt_pk_bf16_f32 v183, v174, v175
    v_lshlrev_b32 v184, 16, v182
    v_and_b32 v185, 0xffff0000, v182
    v_lshlrev_b32 v186, 16, v183
    v_and_b32 v187, 0xffff0000, v183
    v_mul_f32 v184, s76, v184
    v_mul_f32 v185, s76, v185
    v_mul_f32 v186, s76, v186
    v_mul_f32 v187, s76, v187
    v_cvt_pk_bf16_f32 v182, v184, v185
    v_cvt_pk_bf16_f32 v183, v186, v187
    v_lshlrev_b32 v184, 16, v182
    v_and_b32 v185, 0xffff0000, v182
    v_lshlrev_b32 v186, 16, v183
    v_and_b32 v187, 0xffff0000, v183
    v_mul_f32 v184, s77, v184
    v_mul_f32 v185, s77, v185
    v_mul_f32 v186, s77, v186
    v_mul_f32 v187, s77, v187
    v_max3_f32 v188, v184, v185, v186
    v_max3_f32 v188, v188, v187, v180
    v_sub_f32 v189, v180, v188
    v_sub_f32 v176, v184, v188
    v_sub_f32 v177, v185, v188
    v_sub_f32 v178, v186, v188
    v_sub_f32 v179, v187, v188
    v_exp_f32 v189, v189
    v_exp_f32 v176, v176
    v_exp_f32 v177, v177
    v_exp_f32 v178, v178
    v_exp_f32 v179, v179
    v_mov_b32 v180, v188
    v_mul_f32 v136, v189, v136
    v_mul_f32 v137, v189, v137
    v_mul_f32 v138, v189, v138
    v_mul_f32 v139, v189, v139
    v_mul_f32 v140, v189, v140
    v_mul_f32 v141, v189, v141
    v_mul_f32 v142, v189, v142
    v_mul_f32 v143, v189, v143
    v_mul_f32 v144, v189, v144
    v_mul_f32 v145, v189, v145
    v_mul_f32 v146, v189, v146
    v_mul_f32 v147, v189, v147
    v_mul_f32 v148, v189, v148
    v_mul_f32 v149, v189, v149
    v_mul_f32 v150, v189, v150
    v_mul_f32 v151, v189, v151
    v_add_f32 v182, v176, v177
    v_add_f32 v183, v178, v179
    v_add_f32 v182, v182, v183
    v_fma_f32 v181, v181, v189, v182
    v_cndmask_b32 v190, v176, v177, s[64:65]
    v_cndmask_b32 v191, v178, v179, s[64:65]
    s_waitcnt vmcnt(18)
    v_lshlrev_b32 v192, 16, v88
    v_and_b32 v193, 0xffff0000, v88
    v_fmac_f32 v136, v176, v192
    v_fmac_f32 v137, v176, v193
    v_lshlrev_b32 v192, 16, v89
    v_and_b32 v193, 0xffff0000, v89
    v_fmac_f32 v138, v176, v192
    v_fmac_f32 v139, v176, v193
    v_lshlrev_b32 v192, 16, v90
    v_and_b32 v193, 0xffff0000, v90
    v_fmac_f32 v140, v176, v192
    v_fmac_f32 v141, v176, v193
    v_lshlrev_b32 v192, 16, v91
    v_and_b32 v193, 0xffff0000, v91
    v_fmac_f32 v142, v176, v192
    v_fmac_f32 v143, v176, v193
    v_lshlrev_b32 v192, 16, v92
    v_and_b32 v193, 0xffff0000, v92
    v_fmac_f32 v136, v177, v192
    v_fmac_f32 v137, v177, v193
    v_lshlrev_b32 v192, 16, v93
    v_and_b32 v193, 0xffff0000, v93
    v_fmac_f32 v138, v177, v192
    v_fmac_f32 v139, v177, v193
    v_lshlrev_b32 v192, 16, v94
    v_and_b32 v193, 0xffff0000, v94
    v_fmac_f32 v140, v177, v192
    v_fmac_f32 v141, v177, v193
    v_lshlrev_b32 v192, 16, v95
    v_and_b32 v193, 0xffff0000, v95
    v_fmac_f32 v142, v177, v192
    v_fmac_f32 v143, v177, v193
    v_lshlrev_b32 v192, 16, v96
    v_and_b32 v193, 0xffff0000, v96
    v_fmac_f32 v136, v178, v192
    v_fmac_f32 v137, v178, v193
    v_lshlrev_b32 v192, 16, v97
    v_and_b32 v193, 0xffff0000, v97
    v_fmac_f32 v138, v178, v192
    v_fmac_f32 v139, v178, v193
    v_lshlrev_b32 v192, 16, v98
    v_and_b32 v193, 0xffff0000, v98
    v_fmac_f32 v140, v178, v192
    v_fmac_f32 v141, v178, v193
    v_lshlrev_b32 v192, 16, v99
    v_and_b32 v193, 0xffff0000, v99
    v_fmac_f32 v142, v178, v192
    v_fmac_f32 v143, v178, v193
    v_lshlrev_b32 v192, 16, v100
    v_and_b32 v193, 0xffff0000, v100
    v_fmac_f32 v136, v179, v192
    v_fmac_f32 v137, v179, v193
    v_lshlrev_b32 v192, 16, v101
    v_and_b32 v193, 0xffff0000, v101
    v_fmac_f32 v138, v179, v192
    v_fmac_f32 v139, v179, v193
    v_lshlrev_b32 v192, 16, v102
    v_and_b32 v193, 0xffff0000, v102
    v_fmac_f32 v140, v179, v192
    v_fmac_f32 v141, v179, v193
    v_lshlrev_b32 v192, 16, v103
    v_and_b32 v193, 0xffff0000, v103
    v_fmac_f32 v142, v179, v192
    v_fmac_f32 v143, v179, v193
    v_lshlrev_b32 v192, 16, v104
    v_and_b32 v193, 0xffff0000, v104
    v_fmac_f32 v144, v190, v192
    v_fmac_f32 v145, v190, v193
    v_lshlrev_b32 v192, 16, v105
    v_and_b32 v193, 0xffff0000, v105
    v_fmac_f32 v146, v190, v192
    v_fmac_f32 v147, v190, v193
    v_lshlrev_b32 v192, 16, v106
    v_and_b32 v193, 0xffff0000, v106
    v_fmac_f32 v148, v190, v192
    v_fmac_f32 v149, v190, v193
    v_lshlrev_b32 v192, 16, v107
    v_and_b32 v193, 0xffff0000, v107
    v_fmac_f32 v150, v190, v192
    v_fmac_f32 v151, v190, v193
    v_lshlrev_b32 v192, 16, v108
    v_and_b32 v193, 0xffff0000, v108
    v_fmac_f32 v144, v191, v192
    v_fmac_f32 v145, v191, v193
    v_lshlrev_b32 v192, 16, v109
    v_and_b32 v193, 0xffff0000, v109
    v_fmac_f32 v146, v191, v192
    v_fmac_f32 v147, v191, v193
    v_lshlrev_b32 v192, 16, v110
    v_and_b32 v193, 0xffff0000, v110
    v_fmac_f32 v148, v191, v192
    v_fmac_f32 v149, v191, v193
    v_lshlrev_b32 v192, 16, v111
    v_and_b32 v193, 0xffff0000, v111
    v_fmac_f32 v150, v191, v192
    v_fmac_f32 v151, v191, v193
    buffer_load_dwordx4 v[88:91], v5, s[8:11], s67 offen offset:0 nt
    buffer_load_dwordx4 v[92:95], v5, s[8:11], s67 offen offset:384 nt
    buffer_load_dwordx4 v[96:99], v5, s[8:11], s67 offen offset:768 nt
    buffer_load_dwordx4 v[100:103], v5, s[8:11], s67 offen offset:1152 nt
    buffer_load_dwordx4 v[104:107], v6, s[8:11], s67 offen offset:0 nt
    buffer_load_dwordx4 v[108:111], v6, s[8:11], s67 offen offset:768 nt
    s_add_u32 s73, s73, 49152
    s_add_u32 s101, s101, 49152
    s_cmp_eq_u32 s75, 0
    s_cselect_b32 s66, s73, 2130706432
    s_cselect_b32 s67, s101, 2130706432
    s_waitcnt vmcnt(18)
    ds_read_b128 v[16:19], v202 offset:6144
    ds_read_b128 v[20:23], v202 offset:6208
    ds_read_b128 v[24:27], v202 offset:6272
    ds_read_b128 v[28:31], v202 offset:6336
    ds_read_b128 v[32:35], v202 offset:6400
    ds_read_b128 v[36:39], v202 offset:6464
    s_waitcnt lgkmcnt(0)
    s_add_u32 m0, s79, 6144
    s_add_u32 s100, s66, 4096
    buffer_load_dwordx4 v4, s[4:7], s66 offen offset:0 nt lds
    buffer_load_dwordx4 v4, s[4:7], s66 offen offset:1024 nt lds
    buffer_load_dwordx4 v4, s[4:7], s66 offen offset:2048 nt lds
    buffer_load_dwordx4 v4, s[4:7], s66 offen offset:3072 nt lds
    s_add_u32 m0, s79, 10240
    s_nop 0
    buffer_load_dwordx4 v4, s[4:7], s100 offen offset:0 nt lds
    buffer_load_dwordx4 v4, s[4:7], s100 offen offset:1024 nt lds
    v_mfma_f32_16x16x32_bf16 v[172:175], v[16:19], v[112:115], 0
    v_mfma_f32_16x16x32_bf16 v[172:175], v[20:23], v[116:119], v[172:175]
    v_mfma_f32_16x16x32_bf16 v[172:175], v[24:27], v[120:123], v[172:175]
    v_mfma_f32_16x16x32_bf16 v[172:175], v[28:31], v[124:127], v[172:175]
    v_mfma_f32_16x16x32_bf16 v[172:175], v[32:35], v[128:131], v[172:175]
    v_mfma_f32_16x16x32_bf16 v[172:175], v[36:39], v[132:135], v[172:175]
    s_nop 7
    v_cvt_pk_bf16_f32 v182, v172, v173
    v_cvt_pk_bf16_f32 v183, v174, v175
    v_lshlrev_b32 v184, 16, v182
    v_and_b32 v185, 0xffff0000, v182
    v_lshlrev_b32 v186, 16, v183
    v_and_b32 v187, 0xffff0000, v183
    v_mul_f32 v184, s76, v184
    v_mul_f32 v185, s76, v185
    v_mul_f32 v186, s76, v186
    v_mul_f32 v187, s76, v187
    v_cvt_pk_bf16_f32 v182, v184, v185
    v_cvt_pk_bf16_f32 v183, v186, v187
    v_lshlrev_b32 v184, 16, v182
    v_and_b32 v185, 0xffff0000, v182
    v_lshlrev_b32 v186, 16, v183
    v_and_b32 v187, 0xffff0000, v183
    v_mul_f32 v184, s77, v184
    v_mul_f32 v185, s77, v185
    v_mul_f32 v186, s77, v186
    v_mul_f32 v187, s77, v187
    v_max3_f32 v188, v184, v185, v186
    v_max3_f32 v188, v188, v187, v180
    v_sub_f32 v189, v180, v188
    v_sub_f32 v176, v184, v188
    v_sub_f32 v177, v185, v188
    v_sub_f32 v178, v186, v188
    v_sub_f32 v179, v187, v188
    v_exp_f32 v189, v189
    v_exp_f32 v176, v176
    v_exp_f32 v177, v177
    v_exp_f32 v178, v178
    v_exp_f32 v179, v179
    v_mov_b32 v180, v188
    v_mul_f32 v136, v189, v136
    v_mul_f32 v137, v189, v137
    v_mul_f32 v138, v189, v138
    v_mul_f32 v139, v189, v139
    v_mul_f32 v140, v189, v140
    v_mul_f32 v141, v189, v141
    v_mul_f32 v142, v189, v142
    v_mul_f32 v143, v189, v143
    v_mul_f32 v144, v189, v144
    v_mul_f32 v145, v189, v145
    v_mul_f32 v146, v189, v146
    v_mul_f32 v147, v189, v147
    v_mul_f32 v148, v189, v148
    v_mul_f32 v149, v189, v149
    v_mul_f32 v150, v189, v150
    v_mul_f32 v151, v189, v151
    v_add_f32 v182, v176, v177
    v_add_f32 v183, v178, v179
    v_add_f32 v182, v182, v183
    v_fma_f32 v181, v181, v189, v182
    v_cndmask_b32 v190, v176, v177, s[64:65]
    v_cndmask_b32 v191, v178, v179, s[64:65]
    s_waitcnt vmcnt(18)
    v_lshlrev_b32 v192, 16, v204
    v_and_b32 v193, 0xffff0000, v204
    v_fmac_f32 v136, v176, v192
    v_fmac_f32 v137, v176, v193
    v_lshlrev_b32 v192, 16, v205
    v_and_b32 v193, 0xffff0000, v205
    v_fmac_f32 v138, v176, v192
    v_fmac_f32 v139, v176, v193
    v_lshlrev_b32 v192, 16, v206
    v_and_b32 v193, 0xffff0000, v206
    v_fmac_f32 v140, v176, v192
    v_fmac_f32 v141, v176, v193
    v_lshlrev_b32 v192, 16, v207
    v_and_b32 v193, 0xffff0000, v207
    v_fmac_f32 v142, v176, v192
    v_fmac_f32 v143, v176, v193
    v_lshlrev_b32 v192, 16, v208
    v_and_b32 v193, 0xffff0000, v208
    v_fmac_f32 v136, v177, v192
    v_fmac_f32 v137, v177, v193
    v_lshlrev_b32 v192, 16, v209
    v_and_b32 v193, 0xffff0000, v209
    v_fmac_f32 v138, v177, v192
    v_fmac_f32 v139, v177, v193
    v_lshlrev_b32 v192, 16, v210
    v_and_b32 v193, 0xffff0000, v210
    v_fmac_f32 v140, v177, v192
    v_fmac_f32 v141, v177, v193
    v_lshlrev_b32 v192, 16, v211
    v_and_b32 v193, 0xffff0000, v211
    v_fmac_f32 v142, v177, v192
    v_fmac_f32 v143, v177, v193
    v_lshlrev_b32 v192, 16, v212
    v_and_b32 v193, 0xffff0000, v212
    v_fmac_f32 v136, v178, v192
    v_fmac_f32 v137, v178, v193
    v_lshlrev_b32 v192, 16, v213
    v_and_b32 v193, 0xffff0000, v213
    v_fmac_f32 v138, v178, v192
    v_fmac_f32 v139, v178, v193
    v_lshlrev_b32 v192, 16, v214
    v_and_b32 v193, 0xffff0000, v214
    v_fmac_f32 v140, v178, v192
    v_fmac_f32 v141, v178, v193
    v_lshlrev_b32 v192, 16, v215
    v_and_b32 v193, 0xffff0000, v215
    v_fmac_f32 v142, v178, v192
    v_fmac_f32 v143, v178, v193
    v_lshlrev_b32 v192, 16, v216
    v_and_b32 v193, 0xffff0000, v216
    v_fmac_f32 v136, v179, v192
    v_fmac_f32 v137, v179, v193
    v_lshlrev_b32 v192, 16, v217
    v_and_b32 v193, 0xffff0000, v217
    v_fmac_f32 v138, v179, v192
    v_fmac_f32 v139, v179, v193
    v_lshlrev_b32 v192, 16, v218
    v_and_b32 v193, 0xffff0000, v218
    v_fmac_f32 v140, v179, v192
    v_fmac_f32 v141, v179, v193
    v_lshlrev_b32 v192, 16, v219
    v_and_b32 v193, 0xffff0000, v219
    v_fmac_f32 v142, v179, v192
    v_fmac_f32 v143, v179, v193
    v_lshlrev_b32 v192, 16, v220
    v_and_b32 v193, 0xffff0000, v220
    v_fmac_f32 v144, v190, v192
    v_fmac_f32 v145, v190, v193
    v_lshlrev_b32 v192, 16, v221
    v_and_b32 v193, 0xffff0000, v221
    v_fmac_f32 v146, v190, v192
    v_fmac_f32 v147, v190, v193
    v_lshlrev_b32 v192, 16, v222
    v_and_b32 v193, 0xffff0000, v222
    v_fmac_f32 v148, v190, v192
    v_fmac_f32 v149, v190, v193
    v_lshlrev_b32 v192, 16, v223
    v_and_b32 v193, 0xffff0000, v223
    v_fmac_f32 v150, v190, v192
    v_fmac_f32 v151, v190, v193
    v_lshlrev_b32 v192, 16, v224
    v_and_b32 v193, 0xffff0000, v224
    v_fmac_f32 v144, v191, v192
    v_fmac_f32 v145, v191, v193
    v_lshlrev_b32 v192, 16, v225
    v_and_b32 v193, 0xffff0000, v225
    v_fmac_f32 v146, v191, v192
    v_fmac_f32 v147, v191, v193
    v_lshlrev_b32 v192, 16, v226
    v_and_b32 v193, 0xffff0000, v226
    v_fmac_f32 v148, v191, v192
    v_fmac_f32 v149, v191, v193
    v_lshlrev_b32 v192, 16, v227
    v_and_b32 v193, 0xffff0000, v227
    v_fmac_f32 v150, v191, v192
    v_fmac_f32 v151, v191, v193
    buffer_load_dwordx4 v[204:207], v5, s[8:11], s67 offen offset:0 nt
    buffer_load_dwordx4 v[208:211], v5, s[8:11], s67 offen offset:384 nt
    buffer_load_dwordx4 v[212:215], v5, s[8:11], s67 offen offset:768 nt
    buffer_load_dwordx4 v[216:219], v5, s[8:11], s67 offen offset:1152 nt
    buffer_load_dwordx4 v[220:223], v6, s[8:11], s67 offen offset:0 nt
    buffer_load_dwordx4 v[224:227], v6, s[8:11], s67 offen offset:768 nt
    s_add_u32 s73, s73, 49152
    s_add_u32 s101, s101, 49152
    s_add_u32 s75, s75, 1
    s_cmp_lt_u32 s75, 2
    s_cbranch_scc1 L_loop
    s_lshl_b32 s66, s63, 2
    v_add_u32 v8, s66, v2
    v_mul_u32_u24 v8, 1040, v8
    v_lshl_add_u32 v9, v3, 5, v8
    ds_write_b128 v9, v[136:139] offset:0
    ds_write_b128 v9, v[140:143] offset:16
    ds_write_b128 v9, v[144:147] offset:512
    ds_write_b128 v9, v[148:151] offset:528
    v_cmp_eq_u32 vcc, 0, v3
    s_and_saveexec_b64 s[70:71], vcc
    ds_write_b64 v8, v[180:181] offset:1024
    s_mov_b64 exec, s[70:71]
    s_cmp_lg_u32 s63, 1
    s_cbranch_scc1 L_t3_done
    v_lshlrev_b32 v8, 2, v1
L_t3_poll:
    buffer_load_dword v9, v8, s[32:35], 0 offen offset:0 sc1
    s_waitcnt vmcnt(0)
    v_cmp_gt_u32 vcc, 8, v9
    v_cmp_gt_u32 s[82:83], 32, v1
    s_nop 4
    s_and_b64 s[82:83], s[82:83], vcc
    s_cbranch_scc0 L_t3_done
    s_sleep 4
    s_branch L_t3_poll
L_t3_done:
    s_cmp_ge_u32 s63, 4
    s_cbranch_scc1 L_h_done
    v_mov_b32 v8, 51200
    v_mov_b32 v9, 1
    s_waitcnt vmcnt(0) lgkmcnt(0)
    s_mov_b64 s[70:71], exec
    s_mov_b64 exec, 1
    ds_add_u32 v8, v9 offset:8
    s_mov_b64 exec, s[70:71]
    s_cmp_eq_u32 s63, 3
    s_cbranch_scc1 L_h_done
L_h_spin:
    ds_read_b32 v10, v8 offset:8
    s_waitcnt lgkmcnt(0)
    v_readfirstlane_b32 s66, v10
    s_cmp_eq_u32 s66, 4
    s_cbranch_scc1 L_h_go
    s_sleep 4
    s_branch L_h_spin
L_h_go:
    v_mov_b32 v8, 0
    ds_read_b64 v[16:17], v8 offset:1024
    ds_read_b64 v[18:19], v8 offset:2064
    ds_read_b64 v[20:21], v8 offset:3104
    ds_read_b64 v[22:23], v8 offset:4144
    ds_read_b64 v[24:25], v8 offset:5184
    ds_read_b64 v[26:27], v8 offset:6224
    ds_read_b64 v[28:29], v8 offset:7264
    ds_read_b64 v[30:31], v8 offset:8304
    ds_read_b64 v[32:33], v8 offset:9344
    ds_read_b64 v[34:35], v8 offset:10384
    ds_read_b64 v[36:37], v8 offset:11424
    ds_read_b64 v[38:39], v8 offset:12464
    ds_read_b64 v[40:41], v8 offset:13504
    ds_read_b64 v[42:43], v8 offset:14544
    ds_read_b64 v[44:45], v8 offset:15584
    ds_read_b64 v[46:47], v8 offset:16624
    v_lshlrev_b32 v8, 2, v0
    ds_read_b32 v48, v8 offset:0
    ds_read_b32 v49, v8 offset:1040
    ds_read_b32 v50, v8 offset:2080
    ds_read_b32 v51, v8 offset:3120
    ds_read_b32 v52, v8 offset:4160
    ds_read_b32 v53, v8 offset:5200
    ds_read_b32 v54, v8 offset:6240
    ds_read_b32 v55, v8 offset:7280
    ds_read_b32 v56, v8 offset:8320
    ds_read_b32 v57, v8 offset:9360
    ds_read_b32 v58, v8 offset:10400
    ds_read_b32 v59, v8 offset:11440
    ds_read_b32 v60, v8 offset:12480
    ds_read_b32 v61, v8 offset:13520
    ds_read_b32 v62, v8 offset:14560
    ds_read_b32 v63, v8 offset:15600
    s_cmp_lg_u32 s63, 2
    s_cbranch_scc1 L_t2h_a
    ds_read_b32 v64, v8 offset:256
    ds_read_b32 v65, v8 offset:1296
    ds_read_b32 v66, v8 offset:2336
    ds_read_b32 v67, v8 offset:3376
    ds_read_b32 v68, v8 offset:4416
    ds_read_b32 v69, v8 offset:5456
    ds_read_b32 v70, v8 offset:6496
    ds_read_b32 v71, v8 offset:7536
    ds_read_b32 v72, v8 offset:8576
    ds_read_b32 v73, v8 offset:9616
    ds_read_b32 v74, v8 offset:10656
    ds_read_b32 v75, v8 offset:11696
    ds_read_b32 v76, v8 offset:12736
    ds_read_b32 v77, v8 offset:13776
    ds_read_b32 v78, v8 offset:14816
    ds_read_b32 v79, v8 offset:15856
    s_waitcnt lgkmcnt(0)
    v_add_f32 v48, v48, v64
    v_add_f32 v49, v49, v65
    v_add_f32 v50, v50, v66
    v_add_f32 v51, v51, v67
    v_add_f32 v52, v52, v68
    v_add_f32 v53, v53, v69
    v_add_f32 v54, v54, v70
    v_add_f32 v55, v55, v71
    v_add_f32 v56, v56, v72
    v_add_f32 v57, v57, v73
    v_add_f32 v58, v58, v74
    v_add_f32 v59, v59, v75
    v_add_f32 v60, v60, v76
    v_add_f32 v61, v61, v77
    v_add_f32 v62, v62, v78
    v_add_f32 v63, v63, v79
L_t2h_a:
    s_waitcnt lgkmcnt(0)
    v_max3_f32 v9, v16, v18, v20
    v_max3_f32 v9, v9, v22, v24
    v_max3_f32 v9, v9, v26, v28
    v_max3_f32 v9, v9, v30, v32
    v_max3_f32 v9, v9, v34, v36
    v_max3_f32 v9, v9, v38, v40
    v_max3_f32 v9, v9, v42, v44
    v_max_f32 v9, v9, v46
    v_sub_f32 v16, v16, v9
    v_sub_f32 v18, v18, v9
    v_sub_f32 v20, v20, v9
    v_sub_f32 v22, v22, v9
    v_sub_f32 v24, v24, v9
    v_sub_f32 v26, v26, v9
    v_sub_f32 v28, v28, v9
    v_sub_f32 v30, v30, v9
    v_sub_f32 v32, v32, v9
    v_sub_f32 v34, v34, v9
    v_sub_f32 v36, v36, v9
    v_sub_f32 v38, v38, v9
    v_sub_f32 v40, v40, v9
    v_sub_f32 v42, v42, v9
    v_sub_f32 v44, v44, v9
    v_sub_f32 v46, v46, v9
    v_exp_f32 v16, v16
    v_exp_f32 v18, v18
    v_exp_f32 v20, v20
    v_exp_f32 v22, v22
    v_exp_f32 v24, v24
    v_exp_f32 v26, v26
    v_exp_f32 v28, v28
    v_exp_f32 v30, v30
    v_exp_f32 v32, v32
    v_exp_f32 v34, v34
    v_exp_f32 v36, v36
    v_exp_f32 v38, v38
    v_exp_f32 v40, v40
    v_exp_f32 v42, v42
    v_exp_f32 v44, v44
    v_exp_f32 v46, v46
    s_nop 0
    v_mul_f32 v10, v16, v17
    v_mul_f32 v11, v16, v48
    v_fmac_f32 v10, v18, v19
    v_fmac_f32 v11, v18, v49
    v_fmac_f32 v10, v20, v21
    v_fmac_f32 v11, v20, v50
    v_fmac_f32 v10, v22, v23
    v_fmac_f32 v11, v22, v51
    v_fmac_f32 v10, v24, v25
    v_fmac_f32 v11, v24, v52
    v_fmac_f32 v10, v26, v27
    v_fmac_f32 v11, v26, v53
    v_fmac_f32 v10, v28, v29
    v_fmac_f32 v11, v28, v54
    v_fmac_f32 v10, v30, v31
    v_fmac_f32 v11, v30, v55
    v_fmac_f32 v10, v32, v33
    v_fmac_f32 v11, v32, v56
    v_fmac_f32 v10, v34, v35
    v_fmac_f32 v11, v34, v57
    v_fmac_f32 v10, v36, v37
    v_fmac_f32 v11, v36, v58
    v_fmac_f32 v10, v38, v39
    v_fmac_f32 v11, v38, v59
    v_fmac_f32 v10, v40, v41
    v_fmac_f32 v11, v40, v60
    v_fmac_f32 v10, v42, v43
    v_fmac_f32 v11, v42, v61
    v_fmac_f32 v10, v44, v45
    v_fmac_f32 v11, v44, v62
    v_fmac_f32 v10, v46, v47
    v_fmac_f32 v11, v46, v63
    v_mov_b32 v182, v9
    v_mov_b32 v183, v10
    v_mov_b32 v184, v11
L_h_done:
    s_waitcnt vmcnt(0) lgkmcnt(0)
    s_barrier
    s_mul_i32 s66, s3, 245760
    s_mul_i32 s67, s62, 160
    s_add_u32 s66, s66, s67
    buffer_load_dwordx4 v[152:155], v200, s[16:19], s66 offen nt
    s_add_u32 s66, s66, 61440
    buffer_load_dwordx4 v[156:159], v200, s[16:19], s66 offen nt
    s_add_u32 s66, s66, 61440
    buffer_load_dwordx4 v[160:163], v200, s[16:19], s66 offen nt
    s_add_u32 s66, s66, 61440
    buffer_load_dwordx4 v[164:167], v200, s[16:19], s66 offen nt
    s_mul_i32 s66, s3, 61440
    s_add_u32 s66, s66, s67
    buffer_load_dwordx4 v[168:171], v200, s[20:23], s66 offen nt
    s_cmp_ge_u32 s63, 3
    s_cbranch_scc1 L_t_gu
    v_mov_b32 v8, 0
    ds_read_b64 v[16:17], v8 offset:17664
    ds_read_b64 v[18:19], v8 offset:18704
    ds_read_b64 v[20:21], v8 offset:19744
    ds_read_b64 v[22:23], v8 offset:20784
    ds_read_b64 v[24:25], v8 offset:21824
    ds_read_b64 v[26:27], v8 offset:22864
    ds_read_b64 v[28:29], v8 offset:23904
    ds_read_b64 v[30:31], v8 offset:24944
    ds_read_b64 v[32:33], v8 offset:25984
    ds_read_b64 v[34:35], v8 offset:27024
    ds_read_b64 v[36:37], v8 offset:28064
    ds_read_b64 v[38:39], v8 offset:29104
    ds_read_b64 v[40:41], v8 offset:30144
    ds_read_b64 v[42:43], v8 offset:31184
    ds_read_b64 v[44:45], v8 offset:32224
    ds_read_b64 v[46:47], v8 offset:33264
    v_lshlrev_b32 v8, 2, v0
    ds_read_b32 v48, v8 offset:16640
    ds_read_b32 v49, v8 offset:17680
    ds_read_b32 v50, v8 offset:18720
    ds_read_b32 v51, v8 offset:19760
    ds_read_b32 v52, v8 offset:20800
    ds_read_b32 v53, v8 offset:21840
    ds_read_b32 v54, v8 offset:22880
    ds_read_b32 v55, v8 offset:23920
    ds_read_b32 v56, v8 offset:24960
    ds_read_b32 v57, v8 offset:26000
    ds_read_b32 v58, v8 offset:27040
    ds_read_b32 v59, v8 offset:28080
    ds_read_b32 v60, v8 offset:29120
    ds_read_b32 v61, v8 offset:30160
    ds_read_b32 v62, v8 offset:31200
    ds_read_b32 v63, v8 offset:32240
    s_cmp_lg_u32 s63, 2
    s_cbranch_scc1 L_t2h_b
    ds_read_b32 v64, v8 offset:16896
    ds_read_b32 v65, v8 offset:17936
    ds_read_b32 v66, v8 offset:18976
    ds_read_b32 v67, v8 offset:20016
    ds_read_b32 v68, v8 offset:21056
    ds_read_b32 v69, v8 offset:22096
    ds_read_b32 v70, v8 offset:23136
    ds_read_b32 v71, v8 offset:24176
    ds_read_b32 v72, v8 offset:25216
    ds_read_b32 v73, v8 offset:26256
    ds_read_b32 v74, v8 offset:27296
    ds_read_b32 v75, v8 offset:28336
    ds_read_b32 v76, v8 offset:29376
    ds_read_b32 v77, v8 offset:30416
    ds_read_b32 v78, v8 offset:31456
    ds_read_b32 v79, v8 offset:32496
    s_waitcnt lgkmcnt(0)
    v_add_f32 v48, v48, v64
    v_add_f32 v49, v49, v65
    v_add_f32 v50, v50, v66
    v_add_f32 v51, v51, v67
    v_add_f32 v52, v52, v68
    v_add_f32 v53, v53, v69
    v_add_f32 v54, v54, v70
    v_add_f32 v55, v55, v71
    v_add_f32 v56, v56, v72
    v_add_f32 v57, v57, v73
    v_add_f32 v58, v58, v74
    v_add_f32 v59, v59, v75
    v_add_f32 v60, v60, v76
    v_add_f32 v61, v61, v77
    v_add_f32 v62, v62, v78
    v_add_f32 v63, v63, v79
L_t2h_b:
    s_waitcnt lgkmcnt(0)
    v_max3_f32 v9, v16, v18, v20
    v_max3_f32 v9, v9, v22, v24
    v_max3_f32 v9, v9, v26, v28
    v_max3_f32 v9, v9, v30, v32
    v_max3_f32 v9, v9, v34, v36
    v_max3_f32 v9, v9, v38, v40
    v_max3_f32 v9, v9, v42, v44
    v_max_f32 v9, v9, v46
    v_sub_f32 v16, v16, v9
    v_sub_f32 v18, v18, v9
    v_sub_f32 v20, v20, v9
    v_sub_f32 v22, v22, v9
    v_sub_f32 v24, v24, v9
    v_sub_f32 v26, v26, v9
    v_sub_f32 v28, v28, v9
    v_sub_f32 v30, v30, v9
    v_sub_f32 v32, v32, v9
    v_sub_f32 v34, v34, v9
    v_sub_f32 v36, v36, v9
    v_sub_f32 v38, v38, v9
    v_sub_f32 v40, v40, v9
    v_sub_f32 v42, v42, v9
    v_sub_f32 v44, v44, v9
    v_sub_f32 v46, v46, v9
    v_exp_f32 v16, v16
    v_exp_f32 v18, v18
    v_exp_f32 v20, v20
    v_exp_f32 v22, v22
    v_exp_f32 v24, v24
    v_exp_f32 v26, v26
    v_exp_f32 v28, v28
    v_exp_f32 v30, v30
    v_exp_f32 v32, v32
    v_exp_f32 v34, v34
    v_exp_f32 v36, v36
    v_exp_f32 v38, v38
    v_exp_f32 v40, v40
    v_exp_f32 v42, v42
    v_exp_f32 v44, v44
    v_exp_f32 v46, v46
    s_nop 0
    v_mul_f32 v10, v16, v17
    v_mul_f32 v11, v16, v48
    v_fmac_f32 v10, v18, v19
    v_fmac_f32 v11, v18, v49
    v_fmac_f32 v10, v20, v21
    v_fmac_f32 v11, v20, v50
    v_fmac_f32 v10, v22, v23
    v_fmac_f32 v11, v22, v51
    v_fmac_f32 v10, v24, v25
    v_fmac_f32 v11, v24, v52
    v_fmac_f32 v10, v26, v27
    v_fmac_f32 v11, v26, v53
    v_fmac_f32 v10, v28, v29
    v_fmac_f32 v11, v28, v54
    v_fmac_f32 v10, v30, v31
    v_fmac_f32 v11, v30, v55
    v_fmac_f32 v10, v32, v33
    v_fmac_f32 v11, v32, v56
    v_fmac_f32 v10, v34, v35
    v_fmac_f32 v11, v34, v57
    v_fmac_f32 v10, v36, v37
    v_fmac_f32 v11, v36, v58
    v_fmac_f32 v10, v38, v39
    v_fmac_f32 v11, v38, v59
    v_fmac_f32 v10, v40, v41
    v_fmac_f32 v11, v40, v60
    v_fmac_f32 v10, v42, v43
    v_fmac_f32 v11, v42, v61
    v_fmac_f32 v10, v44, v45
    v_fmac_f32 v11, v44, v62
    v_fmac_f32 v10, v46, v47
    v_fmac_f32 v11, v46, v63
    v_max_f32 v12, v9, v182
    v_sub_f32 v13, v9, v12
    v_sub_f32 v14, v182, v12
    v_exp_f32 v13, v13
    v_exp_f32 v14, v14
    v_mov_b32 v9, v12
    v_mul_f32 v10, v10, v13
    v_mul_f32 v11, v11, v13
    v_fmac_f32 v10, v183, v14
    v_fmac_f32 v11, v184, v14
L_t2_pub:
    v_cmp_eq_u32 vcc, -1, v11
    v_mov_b32 v12, 0x7fc00000
    s_nop 1
    v_cndmask_b32 v11, v11, v12, vcc
    v_add_u32 v8, s78, v8
    buffer_store_dword v11, v8, s[24:27], 0 offen offset:1152 sc1
    v_cmp_eq_u32 vcc, -1, v9
    v_mov_b32 v12, 0x7fc00000
    s_nop 1
    v_cndmask_b32 v9, v9, v12, vcc
    v_cmp_eq_u32 vcc, -1, v10
    v_mov_b32 v12, 0x7fc00000
    s_nop 1
    v_cndmask_b32 v10, v10, v12, vcc
    v_cmp_eq_u32 vcc, 0, v0
    v_mov_b32 v12, 0
    s_nop 0
    v_cndmask_b32 v12, v12, v9, vcc
    v_cmp_eq_u32 vcc, 1, v0
    s_nop 1
    v_cndmask_b32 v12, v12, v10, vcc
    v_cmp_gt_u32 vcc, 4, v0
    v_mov_b32 v13, 2130706432
    s_nop 0
    v_cndmask_b32 v8, v13, v8, vcc
    buffer_store_dword v12, v8, s[24:27], 0 offen offset:1920 sc1
L_t_gu:
    v_mov_b32 v13, 2130706432
    s_cmp_gt_u32 s63, 3
    s_cbranch_scc1 L_t5b
    s_cmp_eq_u32 s63, 3
    s_cbranch_scc1 L_t5h
    v_lshlrev_b32 v12, 2, v0
    v_mov_b32 v8, 0
L_op_poll:
    s_lshl_b32 s66, s3, 12
    buffer_load_dword v32, v12, s[24:27], s66 offen offset:1152 sc1
    buffer_load_dwordx2 v[16:17], v8, s[24:27], s66 offen offset:1920 sc1
    s_add_u32 s66, s66, 131072
    buffer_load_dword v33, v12, s[24:27], s66 offen offset:1152 sc1
    buffer_load_dwordx2 v[18:19], v8, s[24:27], s66 offen offset:1920 sc1
    s_add_u32 s66, s66, 131072
    buffer_load_dword v34, v12, s[24:27], s66 offen offset:1152 sc1
    buffer_load_dwordx2 v[20:21], v8, s[24:27], s66 offen offset:1920 sc1
    s_add_u32 s66, s66, 131072
    buffer_load_dword v35, v12, s[24:27], s66 offen offset:1152 sc1
    buffer_load_dwordx2 v[22:23], v8, s[24:27], s66 offen offset:1920 sc1
    s_add_u32 s66, s66, 131072
    buffer_load_dword v36, v12, s[24:27], s66 offen offset:1152 sc1
    buffer_load_dwordx2 v[24:25], v8, s[24:27], s66 offen offset:1920 sc1
    s_add_u32 s66, s66, 131072
    buffer_load_dword v37, v12, s[24:27], s66 offen offset:1152 sc1
    buffer_load_dwordx2 v[26:27], v8, s[24:27], s66 offen offset:1920 sc1
    s_add_u32 s66, s66, 131072
    buffer_load_dword v38, v12, s[24:27], s66 offen offset:1152 sc1
    buffer_load_dwordx2 v[28:29], v8, s[24:27], s66 offen offset:1920 sc1
    s_add_u32 s66, s66, 131072
    buffer_load_dword v39, v12, s[24:27], s66 offen offset:1152 sc1
    buffer_load_dwordx2 v[30:31], v8, s[24:27], s66 offen offset:1920 sc1
    s_waitcnt vmcnt(0)
    v_max3_u32 v11, v16, v17, v18
    v_max3_u32 v11, v11, v19, v20
    v_max3_u32 v11, v11, v21, v22
    v_max3_u32 v11, v11, v23, v24
    v_max3_u32 v11, v11, v25, v26
    v_max3_u32 v11, v11, v27, v28
    v_max3_u32 v11, v11, v29, v30
    v_max3_u32 v11, v11, v31, v32
    v_max3_u32 v11, v11, v33, v34
    v_max3_u32 v11, v11, v35, v36
    v_max3_u32 v11, v11, v37, v38
    v_max_u32 v11, v11, v39
    v_cmp_eq_u32 vcc, -1, v11
    s_nop 4
    s_cbranch_vccz L_op_done
    s_sleep 2
    s_branch L_op_poll
L_op_done:
    v_max3_f32 v9, v16, v18, v20
    v_max3_f32 v9, v9, v22, v24
    v_max3_f32 v9, v9, v26, v28
    v_max_f32 v9, v9, v30
    v_sub_f32 v16, v16, v9
    v_sub_f32 v18, v18, v9
    v_sub_f32 v20, v20, v9
    v_sub_f32 v22, v22, v9
    v_sub_f32 v24, v24, v9
    v_sub_f32 v26, v26, v9
    v_sub_f32 v28, v28, v9
    v_sub_f32 v30, v30, v9
    v_exp_f32 v16, v16
    v_exp_f32 v18, v18
    v_exp_f32 v20, v20
    v_exp_f32 v22, v22
    v_exp_f32 v24, v24
    v_exp_f32 v26, v26
    v_exp_f32 v28, v28
    v_exp_f32 v30, v30
    s_nop 0
    v_mul_f32 v10, v16, v17
    v_mul_f32 v11, v16, v32
    v_fmac_f32 v10, v18, v19
    v_fmac_f32 v11, v18, v33
    v_fmac_f32 v10, v20, v21
    v_fmac_f32 v11, v20, v34
    v_fmac_f32 v10, v22, v23
    v_fmac_f32 v11, v22, v35
    v_fmac_f32 v10, v24, v25
    v_fmac_f32 v11, v24, v36
    v_fmac_f32 v10, v26, v27
    v_fmac_f32 v11, v26, v37
    v_fmac_f32 v10, v28, v29
    v_fmac_f32 v11, v28, v38
    v_fmac_f32 v10, v30, v31
    v_fmac_f32 v11, v30, v39
    v_rcp_f32 v10, v10
    s_nop 0
    v_mul_f32 v11, v11, v10
    v_cvt_pk_bf16_f32 v13, v11, v11
    v_lshlrev_b32 v11, 16, v13
    ds_write_b32 v12, v11 offset:44672
    s_branch L_t5b
L_t5h:
    v_lshlrev_b32 v12, 2, v1
    v_min_u32 v12, 188, v12
    ds_read_b32 v9, v12 offset:41600
    ds_read_b32 v10, v12 offset:41792
    s_waitcnt lgkmcnt(0)
    v_mul_f32 v9, v9, v10
    v_cvt_pk_bf16_f32 v13, v9, v9
    v_lshlrev_b32 v9, 16, v13
    v_cmp_gt_u32 vcc, 48, v1
    s_and_saveexec_b64 s[70:71], vcc
    ds_write_b32 v12, v9 offset:45440
    s_mov_b64 exec, s[70:71]
L_t5b:
    s_waitcnt lgkmcnt(0)
    s_barrier
    v_min_u32 v8, 47, v201
    v_lshlrev_b32 v8, 2, v8
    ds_read_b32 v16, v8 offset:44672
    ds_read_b32 v17, v8 offset:44864
    ds_read_b32 v18, v8 offset:45056
    ds_read_b32 v19, v8 offset:45248
    ds_read_b32 v20, v8 offset:45440
    s_waitcnt vmcnt(0) lgkmcnt(0)
    v_lshlrev_b32 v9, 16, v152
    v_and_b32 v10, 0xffff0000, v152
    v_mul_f32 v24, v16, v9
    v_mul_f32 v25, v16, v10
    v_lshlrev_b32 v9, 16, v153
    v_and_b32 v10, 0xffff0000, v153
    v_mul_f32 v26, v16, v9
    v_mul_f32 v27, v16, v10
    v_lshlrev_b32 v9, 16, v154
    v_and_b32 v10, 0xffff0000, v154
    v_mul_f32 v28, v16, v9
    v_mul_f32 v29, v16, v10
    v_lshlrev_b32 v9, 16, v155
    v_and_b32 v10, 0xffff0000, v155
    v_mul_f32 v30, v16, v9
    v_mul_f32 v31, v16, v10
    v_lshlrev_b32 v9, 16, v156
    v_and_b32 v10, 0xffff0000, v156
    v_fmac_f32 v24, v17, v9
    v_fmac_f32 v25, v17, v10
    v_lshlrev_b32 v9, 16, v157
    v_and_b32 v10, 0xffff0000, v157
    v_fmac_f32 v26, v17, v9
    v_fmac_f32 v27, v17, v10
    v_lshlrev_b32 v9, 16, v158
    v_and_b32 v10, 0xffff0000, v158
    v_fmac_f32 v28, v17, v9
    v_fmac_f32 v29, v17, v10
    v_lshlrev_b32 v9, 16, v159
    v_and_b32 v10, 0xffff0000, v159
    v_fmac_f32 v30, v17, v9
    v_fmac_f32 v31, v17, v10
    v_lshlrev_b32 v9, 16, v160
    v_and_b32 v10, 0xffff0000, v160
    v_fmac_f32 v24, v18, v9
    v_fmac_f32 v25, v18, v10
    v_lshlrev_b32 v9, 16, v161
    v_and_b32 v10, 0xffff0000, v161
    v_fmac_f32 v26, v18, v9
    v_fmac_f32 v27, v18, v10
    v_lshlrev_b32 v9, 16, v162
    v_and_b32 v10, 0xffff0000, v162
    v_fmac_f32 v28, v18, v9
    v_fmac_f32 v29, v18, v10
    v_lshlrev_b32 v9, 16, v163
    v_and_b32 v10, 0xffff0000, v163
    v_fmac_f32 v30, v18, v9
    v_fmac_f32 v31, v18, v10
    v_lshlrev_b32 v9, 16, v164
    v_and_b32 v10, 0xffff0000, v164
    v_fmac_f32 v24, v19, v9
    v_fmac_f32 v25, v19, v10
    v_lshlrev_b32 v9, 16, v165
    v_and_b32 v10, 0xffff0000, v165
    v_fmac_f32 v26, v19, v9
    v_fmac_f32 v27, v19, v10
    v_lshlrev_b32 v9, 16, v166
    v_and_b32 v10, 0xffff0000, v166
    v_fmac_f32 v28, v19, v9
    v_fmac_f32 v29, v19, v10
    v_lshlrev_b32 v9, 16, v167
    v_and_b32 v10, 0xffff0000, v167
    v_fmac_f32 v30, v19, v9
    v_fmac_f32 v31, v19, v10
    v_lshlrev_b32 v9, 16, v168
    v_and_b32 v10, 0xffff0000, v168
    v_mul_f32 v32, v20, v9
    v_mul_f32 v33, v20, v10
    v_lshlrev_b32 v9, 16, v169
    v_and_b32 v10, 0xffff0000, v169
    v_mul_f32 v34, v20, v9
    v_mul_f32 v35, v20, v10
    v_lshlrev_b32 v9, 16, v170
    v_and_b32 v10, 0xffff0000, v170
    v_mul_f32 v36, v20, v9
    v_mul_f32 v37, v20, v10
    v_lshlrev_b32 v9, 16, v171
    v_and_b32 v10, 0xffff0000, v171
    v_mul_f32 v38, v20, v9
    v_mul_f32 v39, v20, v10
    v_lshlrev_b32 v8, 6, v0
    s_mov_b64 s[70:71], exec
    s_mov_b64 exec, s[80:81]
    ds_write_b128 v8, v[24:27] offset:0
    ds_write_b128 v8, v[28:31] offset:16
    ds_write_b128 v8, v[32:35] offset:32
    ds_write_b128 v8, v[36:39] offset:48
    s_mov_b64 exec, s[70:71]
    s_waitcnt lgkmcnt(0)
    s_barrier
    s_cmp_ge_u32 s63, 3
    s_cbranch_scc1 L_t6
    v_min_u32 v8, 159, v0
    v_cmp_lt_u32 vcc, 79, v8
    v_subrev_u32 v9, 80, v8
    s_nop 0
    v_cndmask_b32 v9, v8, v9, vcc
    v_cndmask_b32 v10, 0, 32, vcc
    v_lshrrev_b32 v11, 3, v9
    v_and_b32 v9, 7, v9
    v_lshl_add_u32 v10, v11, 6, v10
    v_lshl_add_u32 v10, v9, 2, v10
    ds_read_b32 v16, v10 offset:0
    ds_read_b32 v17, v10 offset:640
    ds_read_b32 v18, v10 offset:1280
    ds_read_b32 v19, v10 offset:1920
    ds_read_b32 v20, v10 offset:2560
    ds_read_b32 v21, v10 offset:3200
    ds_read_b32 v22, v10 offset:3840
    ds_read_b32 v23, v10 offset:4480
    ds_read_b32 v24, v10 offset:5120
    ds_read_b32 v25, v10 offset:5760
    ds_read_b32 v26, v10 offset:6400
    ds_read_b32 v27, v10 offset:7040
    ds_read_b32 v28, v10 offset:7680
    ds_read_b32 v29, v10 offset:8320
    ds_read_b32 v30, v10 offset:8960
    ds_read_b32 v31, v10 offset:9600
    ds_read_b32 v32, v10 offset:10240
    ds_read_b32 v33, v10 offset:10880
    ds_read_b32 v34, v10 offset:11520
    ds_read_b32 v35, v10 offset:12160
    ds_read_b32 v36, v10 offset:12800
    ds_read_b32 v37, v10 offset:13440
    ds_read_b32 v38, v10 offset:14080
    ds_read_b32 v39, v10 offset:14720
    ds_read_b32 v40, v10 offset:15360
    ds_read_b32 v41, v10 offset:16000
    ds_read_b32 v42, v10 offset:16640
    ds_read_b32 v43, v10 offset:17280
    ds_read_b32 v44, v10 offset:17920
    ds_read_b32 v45, v10 offset:18560
    ds_read_b32 v46, v10 offset:19200
    ds_read_b32 v47, v10 offset:19840
    ds_read_b32 v48, v10 offset:20480
    ds_read_b32 v49, v10 offset:21120
    ds_read_b32 v50, v10 offset:21760
    ds_read_b32 v51, v10 offset:22400
    ds_read_b32 v52, v10 offset:23040
    ds_read_b32 v53, v10 offset:23680
    ds_read_b32 v54, v10 offset:24320
    ds_read_b32 v55, v10 offset:24960
    ds_read_b32 v56, v10 offset:25600
    ds_read_b32 v57, v10 offset:26240
    ds_read_b32 v58, v10 offset:26880
    ds_read_b32 v59, v10 offset:27520
    ds_read_b32 v60, v10 offset:28160
    ds_read_b32 v61, v10 offset:28800
    ds_read_b32 v62, v10 offset:29440
    ds_read_b32 v63, v10 offset:30080
    s_waitcnt lgkmcnt(0)
    v_add_f32 v16, v16, v17
    v_add_f32 v18, v18, v19
    v_add_f32 v16, v16, v18
    v_add_f32 v20, v20, v21
    v_add_f32 v22, v22, v23
    v_add_f32 v20, v20, v22
    v_add_f32 v24, v24, v25
    v_add_f32 v26, v26, v27
    v_add_f32 v24, v24, v26
    v_add_f32 v28, v28, v29
    v_add_f32 v30, v30, v31
    v_add_f32 v28, v28, v30
    v_add_f32 v32, v32, v33
    v_add_f32 v34, v34, v35
    v_add_f32 v32, v32, v34
    v_add_f32 v36, v36, v37
    v_add_f32 v38, v38, v39
    v_add_f32 v36, v36, v38
    v_add_f32 v40, v40, v41
    v_add_f32 v42, v42, v43
    v_add_f32 v40, v40, v42
    v_add_f32 v44, v44, v45
    v_add_f32 v46, v46, v47
    v_add_f32 v44, v44, v46
    v_add_f32 v48, v48, v49
    v_add_f32 v50, v50, v51
    v_add_f32 v48, v48, v50
    v_add_f32 v52, v52, v53
    v_add_f32 v54, v54, v55
    v_add_f32 v52, v52, v54
    v_add_f32 v56, v56, v57
    v_add_f32 v58, v58, v59
    v_add_f32 v56, v56, v58
    v_add_f32 v60, v60, v61
    v_add_f32 v62, v62, v63
    v_add_f32 v60, v60, v62
    v_add_f32 v16, v16, v20
    v_add_f32 v16, v16, v24
    v_add_f32 v16, v16, v28
    v_add_f32 v16, v16, v32
    v_add_f32 v16, v16, v36
    v_add_f32 v16, v16, v40
    v_add_f32 v16, v16, v44
    v_add_f32 v16, v16, v48
    v_add_f32 v16, v16, v52
    v_add_f32 v16, v16, v56
    v_add_f32 v16, v16, v60
    v_cmp_eq_u32 vcc, -1, v16
    v_mov_b32 v12, 0x7fc00000
    s_nop 1
    v_cndmask_b32 v16, v16, v12, vcc
    v_lshl_add_u32 v8, v0, 2, s78
    v_cmp_gt_u32 vcc, 160, v0
    v_mov_b32 v13, 2130706432
    s_nop 0
    v_cndmask_b32 v8, v13, v8, vcc
    buffer_store_dword v16, v8, s[24:27], 0 offen offset:2048 sc1
L_t6:
    s_cmp_lg_u32 s3, 0
    s_cbranch_scc1 L_fin
    s_cmp_eq_u32 s63, 7
    s_cbranch_scc1 L_gate
    s_cmp_ge_u32 s63, 5
    s_cbranch_scc1 L_fin_bar
    v_mul_u32_u24 v9, 1639, v0
    v_lshrrev_b32 v9, 16, v9
    v_mul_u32_u24 v10, 40, v9
    v_sub_u32 v10, v0, v10
    v_lshlrev_b32 v9, 14, v9
    v_lshl_add_u32 v9, v10, 4, v9
    s_lshl_b32 s66, s62, 17
    s_add_u32 s67, s66, 4096
    s_add_u32 s68, s66, 8192
    s_add_u32 s69, s66, 12288
L_ap_poll:
    buffer_load_dwordx4 v[16:19], v9, s[24:27], s66 offen offset:2048 sc1
    buffer_load_dwordx4 v[20:23], v9, s[24:27], s67 offen offset:2048 sc1
    buffer_load_dwordx4 v[24:27], v9, s[24:27], s68 offen offset:2048 sc1
    buffer_load_dwordx4 v[28:31], v9, s[24:27], s69 offen offset:2048 sc1
    s_waitcnt vmcnt(0)
    v_max3_u32 v11, v16, v17, v18
    v_max3_u32 v11, v11, v19, v20
    v_max3_u32 v11, v11, v21, v22
    v_max3_u32 v11, v11, v23, v24
    v_max3_u32 v11, v11, v25, v26
    v_max3_u32 v11, v11, v27, v28
    v_max3_u32 v11, v11, v29, v30
    v_max_u32 v11, v11, v31
    v_cmp_eq_u32 vcc, -1, v11
    s_nop 4
    s_cbranch_vccz L_ap_done
    s_sleep 2
    s_branch L_ap_poll
L_ap_light:
    v_lshlrev_b32 v12, 12, v1
    v_cmp_gt_u32 vcc, 32, v1
    v_mov_b32 v13, 2130706432
    s_nop 0
    v_cndmask_b32 v12, v13, v12, vcc
L_ap_light2:
    buffer_load_dword v11, v12, s[24:27], s66 offen offset:2048 sc1
    s_waitcnt vmcnt(0)
    v_cmp_eq_u32 vcc, -1, v11
    s_nop 4
    s_cbranch_vccz L_ap_poll
    s_sleep 8
    s_branch L_ap_light2
L_ap_done:
    v_add_f32 v16, v16, v20
    v_add_f32 v24, v24, v28
    v_add_f32 v17, v17, v21
    v_add_f32 v25, v25, v29
    v_add_f32 v18, v18, v22
    v_add_f32 v26, v26, v30
    v_add_f32 v19, v19, v23
    v_add_f32 v27, v27, v31
    v_add_f32 v16, v16, v24
    v_add_f32 v17, v17, v25
    v_add_f32 v18, v18, v26
    v_add_f32 v19, v19, v27
    v_lshlrev_b32 v8, 4, v0
    ds_write_b128 v8, v[16:19] offset:46080
    s_branch L_fin_bar
L_gate:
    v_lshlrev_b32 v8, 5, v1
    buffer_load_dwordx4 v[16:19], v8, s[28:31], 0 offen
    buffer_load_dwordx4 v[20:23], v8, s[28:31], 0 offen offset:16
    buffer_load_dwordx4 v[24:27], v8, s[84:87], 0 offen
    buffer_load_dwordx4 v[28:31], v8, s[84:87], 0 offen offset:16
    v_mov_b32 v9, 0
    s_waitcnt vmcnt(0)
    v_lshlrev_b32 v10, 16, v16
    v_lshlrev_b32 v11, 16, v24
    v_and_b32 v12, 0xffff0000, v16
    v_and_b32 v13, 0xffff0000, v24
    v_mul_f32 v10, v10, v11
    v_mul_f32 v12, v12, v13
    v_cvt_pk_bf16_f32 v10, v10, v12
    v_lshlrev_b32 v11, 16, v10
    v_and_b32 v12, 0xffff0000, v10
    v_add_f32 v9, v9, v11
    v_add_f32 v9, v9, v12
    v_lshlrev_b32 v10, 16, v17
    v_lshlrev_b32 v11, 16, v25
    v_and_b32 v12, 0xffff0000, v17
    v_and_b32 v13, 0xffff0000, v25
    v_mul_f32 v10, v10, v11
    v_mul_f32 v12, v12, v13
    v_cvt_pk_bf16_f32 v10, v10, v12
    v_lshlrev_b32 v11, 16, v10
    v_and_b32 v12, 0xffff0000, v10
    v_add_f32 v9, v9, v11
    v_add_f32 v9, v9, v12
    v_lshlrev_b32 v10, 16, v18
    v_lshlrev_b32 v11, 16, v26
    v_and_b32 v12, 0xffff0000, v18
    v_and_b32 v13, 0xffff0000, v26
    v_mul_f32 v10, v10, v11
    v_mul_f32 v12, v12, v13
    v_cvt_pk_bf16_f32 v10, v10, v12
    v_lshlrev_b32 v11, 16, v10
    v_and_b32 v12, 0xffff0000, v10
    v_add_f32 v9, v9, v11
    v_add_f32 v9, v9, v12
    v_lshlrev_b32 v10, 16, v19
    v_lshlrev_b32 v11, 16, v27
    v_and_b32 v12, 0xffff0000, v19
    v_and_b32 v13, 0xffff0000, v27
    v_mul_f32 v10, v10, v11
    v_mul_f32 v12, v12, v13
    v_cvt_pk_bf16_f32 v10, v10, v12
    v_lshlrev_b32 v11, 16, v10
    v_and_b32 v12, 0xffff0000, v10
    v_add_f32 v9, v9, v11
    v_add_f32 v9, v9, v12
    v_lshlrev_b32 v10, 16, v20
    v_lshlrev_b32 v11, 16, v28
    v_and_b32 v12, 0xffff0000, v20
    v_and_b32 v13, 0xffff0000, v28
    v_mul_f32 v10, v10, v11
    v_mul_f32 v12, v12, v13
    v_cvt_pk_bf16_f32 v10, v10, v12
    v_lshlrev_b32 v11, 16, v10
    v_and_b32 v12, 0xffff0000, v10
    v_add_f32 v9, v9, v11
    v_add_f32 v9, v9, v12
    v_lshlrev_b32 v10, 16, v21
    v_lshlrev_b32 v11, 16, v29
    v_and_b32 v12, 0xffff0000, v21
    v_and_b32 v13, 0xffff0000, v29
    v_mul_f32 v10, v10, v11
    v_mul_f32 v12, v12, v13
    v_cvt_pk_bf16_f32 v10, v10, v12
    v_lshlrev_b32 v11, 16, v10
    v_and_b32 v12, 0xffff0000, v10
    v_add_f32 v9, v9, v11
    v_add_f32 v9, v9, v12
    v_lshlrev_b32 v10, 16, v22
    v_lshlrev_b32 v11, 16, v30
    v_and_b32 v12, 0xffff0000, v22
    v_and_b32 v13, 0xffff0000, v30
    v_mul_f32 v10, v10, v11
    v_mul_f32 v12, v12, v13
    v_cvt_pk_bf16_f32 v10, v10, v12
    v_lshlrev_b32 v11, 16, v10
    v_and_b32 v12, 0xffff0000, v10
    v_add_f32 v9, v9, v11
    v_add_f32 v9, v9, v12
    v_lshlrev_b32 v10, 16, v23
    v_lshlrev_b32 v11, 16, v31
    v_and_b32 v12, 0xffff0000, v23
    v_and_b32 v13, 0xffff0000, v31
    v_mul_f32 v10, v10, v11
    v_mul_f32 v12, v12, v13
    v_cvt_pk_bf16_f32 v10, v10, v12
    v_lshlrev_b32 v11, 16, v10
    v_and_b32 v12, 0xffff0000, v10
    v_add_f32 v9, v9, v11
    v_add_f32 v9, v9, v12
    v_lshlrev_b32 v8, 2, v1
    v_xor_b32 v10, 4, v8
    ds_bpermute_b32 v11, v10, v9
    s_waitcnt lgkmcnt(0)
    v_add_f32 v9, v9, v11
    v_xor_b32 v10, 8, v8
    ds_bpermute_b32 v11, v10, v9
    s_waitcnt lgkmcnt(0)
    v_add_f32 v9, v9, v11
    v_xor_b32 v10, 16, v8
    ds_bpermute_b32 v11, v10, v9
    s_waitcnt lgkmcnt(0)
    v_add_f32 v9, v9, v11
    v_xor_b32 v10, 32, v8
    ds_bpermute_b32 v11, v10, v9
    s_waitcnt lgkmcnt(0)
    v_add_f32 v9, v9, v11
    v_xor_b32 v10, 64, v8
    ds_bpermute_b32 v11, v10, v9
    s_waitcnt lgkmcnt(0)
    v_add_f32 v9, v9, v11
    v_xor_b32 v10, 128, v8
    ds_bpermute_b32 v11, v10, v9
    s_waitcnt lgkmcnt(0)
    v_add_f32 v9, v9, v11
    v_cvt_pk_bf16_f32 v13, v9, v9
    v_lshlrev_b32 v9, 16, v13
    v_mul_f32 v9, s77, v9
    v_sub_f32 v9, 0, v9
    v_exp_f32 v9, v9
    s_nop 0
    v_add_f32 v9, 1.0, v9
    v_rcp_f32 v9, v9
    s_nop 0
    v_cvt_pk_bf16_f32 v13, v9, v9
    v_lshlrev_b32 v9, 16, v13
    v_mov_b32 v8, 0
    ds_write_b32 v8, v9 offset:45632
L_fin_bar:
    s_waitcnt lgkmcnt(0)
    s_barrier
    s_cmp_ge_u32 s63, 2
    s_cbranch_scc1 L_fin
    v_min_u32 v8, 79, v0
    v_lshlrev_b32 v8, 2, v8
    v_mov_b32 v12, 0
    ds_read_b32 v16, v8 offset:46080
    ds_read_b32 v24, v8 offset:46400
    ds_read_b32 v17, v8 offset:46720
    ds_read_b32 v25, v8 offset:47040
    ds_read_b32 v18, v8 offset:47360
    ds_read_b32 v26, v8 offset:47680
    ds_read_b32 v19, v8 offset:48000
    ds_read_b32 v27, v8 offset:48320
    ds_read_b32 v20, v8 offset:48640
    ds_read_b32 v28, v8 offset:48960
    ds_read_b32 v21, v8 offset:49280
    ds_read_b32 v29, v8 offset:49600
    ds_read_b32 v22, v8 offset:49920
    ds_read_b32 v30, v8 offset:50240
    ds_read_b32 v23, v8 offset:50560
    ds_read_b32 v31, v8 offset:50880
    ds_read_b32 v14, v12 offset:45632
    s_waitcnt lgkmcnt(0)
    v_add_f32 v9, v16, v17
    v_add_f32 v10, v24, v25
    v_add_f32 v9, v9, v18
    v_add_f32 v10, v10, v26
    v_add_f32 v9, v9, v19
    v_add_f32 v10, v10, v27
    v_add_f32 v9, v9, v20
    v_add_f32 v10, v10, v28
    v_add_f32 v9, v9, v21
    v_add_f32 v10, v10, v29
    v_add_f32 v9, v9, v22
    v_add_f32 v10, v10, v30
    v_add_f32 v9, v9, v23
    v_add_f32 v10, v10, v31
    v_cvt_pk_bf16_f32 v13, v9, v9
    v_lshlrev_b32 v9, 16, v13
    v_cvt_pk_bf16_f32 v13, v10, v10
    v_lshlrev_b32 v10, 16, v13
    v_sub_f32 v11, 1.0, v14
    v_cvt_pk_bf16_f32 v13, v11, v11
    v_lshlrev_b32 v11, 16, v13
    v_mul_f32 v9, v14, v9
    v_mul_f32 v10, v11, v10
    v_cvt_pk_bf16_f32 v13, v9, v9
    v_lshlrev_b32 v9, 16, v13
    v_cvt_pk_bf16_f32 v13, v10, v10
    v_lshlrev_b32 v10, 16, v13
    v_add_f32 v9, v9, v10
    v_cvt_pk_bf16_f32 v9, v9, v9
    s_mul_i32 s66, s62, 160
    v_lshlrev_b32 v8, 1, v0
    v_cmp_gt_u32 vcc, 80, v0
    v_mov_b32 v13, 2130706432
    s_nop 0
    v_cndmask_b32 v8, v13, v8, vcc
    buffer_store_short v9, v8, s[88:91], s66 offen
L_fin:
L_end:
    s_endpgm
.section .rodata,"a"
.p2align 6
.amdhsa_kernel gated_mix__gqa_block_cached__glu_gated_bilinear__decode_kernel
  .amdhsa_next_free_vgpr 256
  .amdhsa_next_free_sgpr 102
  .amdhsa_accum_offset 256
  .amdhsa_group_segment_fixed_size 0
  .amdhsa_kernarg_size 104
  .amdhsa_user_sgpr_count 2
  .amdhsa_user_sgpr_kernarg_segment_ptr 1
  .amdhsa_system_sgpr_workgroup_id_x 1
.end_amdhsa_kernel
```
